```python
import torch

def _softmax(x, axis=-1):
    return torch.softmax(x, dim=axis)
def _gelu(x):
    return torch.nn.functional.gelu(x, approximate="tanh")
def _silu(x):
    return torch.nn.functional.silu(x)
def _sigmoid(x):
    return torch.sigmoid(x)
def _layernorm(x, axis=-1, eps=1e-5):
    m = x.mean(dim=axis, keepdim=True)
    v = x.var(dim=axis, keepdim=True, unbiased=False)
    return (x - m) / torch.sqrt(v + eps)
def _scatter_add(tgt, idx, src, axis=0):
    return tgt.clone().index_add_(axis, idx, src)
def _segment_sum(src, seg, n):
    out = torch.zeros((n,) + src.shape[1:], dtype=src.dtype)
    return out.index_add_(0, seg, src)
def _pad(x, pw):
    flat = tuple(v for pair in reversed(pw) for v in pair)
    return torch.nn.functional.pad(x, flat)

kernel_name = 'concat_heads__mha_block_cached__mha_block_cached__near_ridge'

def setup_inputs():

    _w = (lambda a: (lambda t: t.to(torch.bfloat16) if t.is_floating_point() else t)(torch.as_tensor(a)))
    def _A_setup():
        B, Sq, D = 8, 128, 1024
        H, Sk, Dh = 32, 1024, 128
        return {
            "x": _w((lambda *s: torch.randn(*s, dtype=torch.bfloat16) * 0.8)(B, Sq, D)),
            "k_cache": _w((lambda *s: torch.randn(*s, dtype=torch.bfloat16) * 0.8)(B, H, Sk, Dh)),
            "v_cache": _w((lambda *s: torch.randn(*s, dtype=torch.bfloat16) * 0.05)(B, H, Sk, Dh)),
            "wq": _w((lambda *s: torch.randn(*s, dtype=torch.bfloat16) * 0.8)(D, H * Dh) * (D ** -0.5)),
            "wo": _w((lambda *s: torch.randn(*s, dtype=torch.bfloat16) * 0.05)(H * Dh, D) * ((H * Dh) ** -0.5)),
        }
    _A_in = _A_setup()

    def _B_setup():
        B, Sq, D = 8, 128, 1024
        H, Sk, Dh = 32, 1024, 128
        return {
            "x": _w((lambda *s: torch.randn(*s, dtype=torch.bfloat16) * 0.8)(B, Sq, D)),
            "k_cache": _w((lambda *s: torch.randn(*s, dtype=torch.bfloat16) * 0.8)(B, H, Sk, Dh)),
            "v_cache": _w((lambda *s: torch.randn(*s, dtype=torch.bfloat16) * 0.05)(B, H, Sk, Dh)),
            "wq": _w((lambda *s: torch.randn(*s, dtype=torch.bfloat16) * 0.8)(D, H * Dh) * (D ** -0.5)),
            "wo": _w((lambda *s: torch.randn(*s, dtype=torch.bfloat16) * 0.05)(H * Dh, D) * ((H * Dh) ** -0.5)),
        }
    _B_in = _B_setup()

    return {
        "A_x": _A_in["x"],
        "A_k_cache": _A_in["k_cache"],
        "A_v_cache": _A_in["v_cache"],
        "A_wq": _A_in["wq"],
        "A_wo": _A_in["wo"],
        "B_x": _B_in["x"],
        "B_k_cache": _B_in["k_cache"],
        "B_v_cache": _B_in["v_cache"],
        "B_wq": _B_in["wq"],
        "B_wo": _B_in["wo"],
    }

def reference(A_x, A_k_cache, A_v_cache, A_wq, A_wo, B_x, B_k_cache, B_v_cache, B_wq, B_wo):
    def _A_ref(x, k_cache, v_cache, wq, wo):
        B, Sq, D = x.shape
        H, Dh = 32, 128
        q = (lambda x, *d: x.permute(*d))((x @ wq).reshape(B, Sq, H, Dh), 0, 2, 1, 3)
        scores = torch.einsum("bhqd,bhkd->bhqk", q, k_cache) * (Dh ** -0.5)
        p = _softmax(scores, axis=-1)
        o = torch.einsum("bhqk,bhkd->bhqd", p, v_cache)
        return (lambda x, *d: x.permute(*d))(o, 0, 2, 1, 3).reshape(B, Sq, H * Dh) @ wo

    def _B_ref(x, k_cache, v_cache, wq, wo):
        B, Sq, D = x.shape
        H, Dh = 32, 128
        q = (lambda x, *d: x.permute(*d))((x @ wq).reshape(B, Sq, H, Dh), 0, 2, 1, 3)
        scores = torch.einsum("bhqd,bhkd->bhqk", q, k_cache) * (Dh ** -0.5)
        p = _softmax(scores, axis=-1)
        o = torch.einsum("bhqk,bhkd->bhqd", p, v_cache)
        return (lambda x, *d: x.permute(*d))(o, 0, 2, 1, 3).reshape(B, Sq, H * Dh) @ wo

    a = _A_ref(A_x, A_k_cache, A_v_cache, A_wq, A_wo)
    b = _B_ref(B_x, B_k_cache, B_v_cache, B_wq, B_wo)
    return torch.concatenate([a, b], axis=-1)
```

```asm
; @launch grid=(256,1,1) block=(512,1,1) lds=163840
.amdgcn_target "amdgcn-amd-amdhsa--gfx950"
.text
.globl concat_heads__mha_block_cached__mha_block_cached__near_ridge_kernel
.p2align 8
.type concat_heads__mha_block_cached__mha_block_cached__near_ridge_kernel,@function
concat_heads__mha_block_cached__mha_block_cached__near_ridge_kernel:
s_cmp_ge_u32 s2, 256
s_cbranch_scc1 concat_heads__mha_block_cached__mha_block_cached__near_ridge_kernel_end
s_load_dwordx8 s[32:39], s[0:1], 0
s_load_dwordx8 s[40:47], s[0:1], 32
s_load_dwordx4 s[48:51], s[0:1], 64
s_load_dwordx2 s[52:53], s[0:1], 80
s_load_dwordx2 s[54:55], s[0:1], 96
s_load_dwordx2 s[56:57], s[0:1], 88
v_lshrrev_b32 v1, 6, v0
v_and_b32 v0, 63, v0
s_and_b32 s77, s2, 7
v_readfirstlane_b32 s64, v1
s_lshr_b32 s67, s77, 2
s_lshr_b32 s78, s2, 3
s_and_b32 s65, s77, 3
s_lshl_b32 s65, s65, 2
s_and_b32 s79, s78, 3
s_add_u32 s65, s65, s79
s_lshl_b32 s65, s65, 1
s_lshr_b32 s66, s78, 2
s_mul_i32 s68, s79, 1
s_add_u32 s68, s68, s66
s_and_b32 s68, s68, 3
s_mul_i32 s68, s68, 2
s_cmp_lt_u32 s64, 4
s_cbranch_scc1 c1_start
l1_start:
s_sub_u32 s71, s64, 4
s_lshl_b32 s74, s71, 12
s_lshl_b32 s75, s71, 11
v_bfe_u32 v24, v0, 4, 2
v_bfe_u32 v25, v0, 0, 4
v_bfe_u32 v26, v0, 3, 3
v_bfe_u32 v27, v0, 0, 3
s_lshl_b32 s78, s71, 15
v_xor_b32 v29, v24, v27
v_lshlrev_b32 v29, 4, v29
v_lshl_add_u32 v29, v26, 11, v29
v_add_u32 v8, s78, v29
v_xor_b32 v29, 64, v8
v_add_u32 v9, 15360, v29
s_and_b32 s79, s71, 1
s_lshl_b32 s79, s79, 3
s_lshl_b32 s78, s71, 16
v_lshl_or_b32 v29, v24, 1, s79
v_xor_b32 v29, v29, v25
v_lshlrev_b32 v29, 4, v29
v_lshl_add_u32 v29, v24, 13, v29
v_add_u32 v4, s78, v29
v_add_u32 v5, 31744, v4
s_lshl_b32 s60, s65, 8
s_lshl_b32 s61, s66, 18
s_cmp_eq_u32 s67, 0
s_waitcnt lgkmcnt(0)
s_cselect_b32 s4, s32, s42
s_cselect_b32 s5, s33, s43
s_mov_b32 s6, 2097152
s_mov_b32 s7, 0x20000
s_cselect_b32 s16, s38, s48
s_cselect_b32 s17, s39, s49
s_mov_b32 s18, 8388608
s_mov_b32 s19, 0x20000
s_add_u32 s79, s68, 0
s_and_b32 s79, s79, 7
s_or_b32 s79, s79, 0
s_lshl_b32 s73, s79, 7
s_add_u32 s73, s73, s61
s_add_u32 m0, s75, 65536
s_add_u32 s73, s73, 0
buffer_load_dwordx4 v8, s[4:7], s73 offen lds
buffer_load_dwordx4 v9, s[4:7], s73 offen offset:1024 lds
s_add_u32 s79, s68, 0
s_and_b32 s79, s79, 7
s_or_b32 s79, s79, 0
s_lshl_b32 s72, s79, 19
s_add_u32 s72, s72, s60
s_add_u32 m0, s75, 0
s_add_u32 s72, s72, 0
buffer_load_dwordx4 v4, s[16:19], s72 offen lds
buffer_load_dwordx4 v5, s[16:19], s72 offen offset:1024 lds
s_add_u32 s79, s68, 0
s_and_b32 s79, s79, 7
s_or_b32 s79, s79, 0
s_lshl_b32 s72, s79, 19
s_add_u32 s72, s72, s60
s_add_u32 m0, s75, 8192
s_add_u32 s72, s72, 256
buffer_load_dwordx4 v4, s[16:19], s72 offen lds
buffer_load_dwordx4 v5, s[16:19], s72 offen offset:1024 lds
s_add_u32 s79, s68, 0
s_and_b32 s79, s79, 7
s_or_b32 s79, s79, 0
s_lshl_b32 s73, s79, 7
s_add_u32 s73, s73, s61
s_add_u32 m0, s75, 73728
s_add_u32 s73, s73, 131072
buffer_load_dwordx4 v8, s[4:7], s73 offen lds
buffer_load_dwordx4 v9, s[4:7], s73 offen offset:1024 lds
s_and_b32 s77, s2, 7
s_lshr_b32 s78, s2, 3
s_bfe_u32 s58, s77, 0x10001
s_lshl_b32 s58, s58, 2
s_lshr_b32 s79, s78, 3
s_add_u32 s58, s58, s79
s_and_b32 s80, s77, 1
s_lshl_b32 s80, s80, 3
s_and_b32 s72, s78, 7
s_add_u32 s80, s80, s72
s_lshr_b32 s72, s72, 1
s_add_u32 s59, s79, s72
s_and_b32 s59, s59, 3
s_lshl_b32 s59, s59, 2
s_mov_b32 s62, 0
s_and_b32 s63, s78, 1
s_cmp_eq_u32 s67, 0
s_waitcnt lgkmcnt(0)
s_cselect_b32 s8, s34, s44
s_cselect_b32 s9, s35, s45
s_mov_b32 s10, 67108864
s_mov_b32 s11, 0x20000
s_cselect_b32 s12, s36, s46
s_cselect_b32 s13, s37, s47
s_mov_b32 s14, 67108864
s_mov_b32 s15, 0x20000
s_cselect_b32 s24, s40, s50
s_cselect_b32 s25, s41, s51
s_mov_b32 s26, 8388608
s_mov_b32 s27, 0x20000
s_mov_b32 s20, s54
s_mov_b32 s21, s55
s_mov_b32 s22, 16777216
s_mov_b32 s23, 0x20000
s_lshr_b32 s78, s65, 1
s_add_u32 s78, s78, s66
s_and_b32 s62, s78, 3
s_lshr_b32 s78, s65, 1
s_lshl_b32 s79, s66, 4
s_add_u32 s78, s78, s79
s_lshl_b32 s78, s78, 2
s_add_u32 s78, s78, s71
s_lshl_b32 s78, s78, 14
v_lshlrev_b32 v30, 7, v0
v_add_u32 v30, s78, v30
s_lshr_b32 s79, s78, 19
s_lshl_b32 s79, s79, 19
s_bfe_u32 s78, s78, 0x5000e
s_lshl_b32 s78, s78, 13
s_add_u32 s78, s78, s79
s_add_u32 s78, s78, 262144
v_lshrrev_b32 v30, 3, v0
v_lshlrev_b32 v30, 10, v30
v_and_b32 v31, 7, v0
v_lshl_add_u32 v30, v31, 4, v30
v_add_u32 v30, s78, v30
s_lshl_b32 s78, s71, 3
s_add_u32 s78, s78, 0
v_add_u32 v28, s78, v24
v_and_b32 v29, 15, v28
v_xor_b32 v29, v29, v25
v_lshlrev_b32 v29, 4, v29
v_lshl_add_u32 v29, v28, 8, v29
v_subrev_u32 v1, 0, v29
s_lshl_b32 s78, s71, 3
s_add_u32 s78, s78, 4
v_add_u32 v28, s78, v24
v_and_b32 v29, 15, v28
v_xor_b32 v29, v29, v25
v_lshlrev_b32 v29, 4, v29
v_lshl_add_u32 v29, v28, 8, v29
v_subrev_u32 v2, 1024, v29
s_lshl_b32 s78, s71, 4
s_add_u32 s78, s78, 0
v_add_u32 v28, s78, v24
v_lshlrev_b32 v29, 2, v24
v_xor_b32 v29, v29, v25
v_lshlrev_b32 v29, 4, v29
v_lshl_add_u32 v29, v28, 8, v29
v_subrev_u32 v3, 0, v29
s_lshl_b32 s78, s71, 4
s_add_u32 s78, s78, 0
v_add_u32 v28, s78, v26
v_lshlrev_b32 v29, 1, v24
v_xor_b32 v29, v29, v27
v_lshlrev_b32 v29, 4, v29
v_lshl_add_u32 v29, v28, 11, v29
v_subrev_u32 v13, 0, v29
s_lshl_b32 s78, s71, 4
s_add_u32 s78, s78, 8
v_add_u32 v28, s78, v26
v_lshlrev_b32 v29, 1, v24
v_xor_b32 v29, v29, v27
v_lshlrev_b32 v29, 4, v29
v_lshl_add_u32 v29, v28, 11, v29
v_subrev_u32 v14, 1024, v29
v_lshlrev_b32 v12, 4, v0
v_add_u32 v15, s75, v12
s_add_u32 s78, s74, 0x10000
v_add_u32 v18, s78, v12
s_lshl_b32 s76, s66, 5
s_add_u32 s76, s76, s65
s_lshl_b32 s76, s76, 18
s_lshl_b32 s81, s67, 3
s_add_u32 s81, s81, s58
s_lshl_b32 s78, s81, 4
v_mov_b32 v17, s78
s_lshl_b32 s81, s81, 20
s_lshl_b32 s78, s71, 13
s_add_u32 s81, s81, s78
s_lshl_b32 s80, s80, 7
s_waitcnt vmcnt(8)
s_barrier
s_add_u32 s79, s68, 0
s_and_b32 s79, s79, 7
s_or_b32 s79, s79, 0
s_lshl_b32 s72, s79, 19
s_add_u32 s72, s72, s60
s_add_u32 m0, s75, 16384
s_add_u32 s72, s72, 262144
buffer_load_dwordx4 v4, s[16:19], s72 offen lds
buffer_load_dwordx4 v5, s[16:19], s72 offen offset:1024 lds
s_add_u32 s79, s68, 0
s_and_b32 s79, s79, 7
s_or_b32 s79, s79, 0
s_lshl_b32 s72, s79, 19
s_add_u32 s72, s72, s60
s_add_u32 m0, s75, 24576
s_add_u32 s72, s72, 262400
buffer_load_dwordx4 v4, s[16:19], s72 offen lds
buffer_load_dwordx4 v5, s[16:19], s72 offen offset:1024 lds
s_add_u32 s79, s68, 1
s_and_b32 s79, s79, 7
s_or_b32 s79, s79, 0
s_lshl_b32 s73, s79, 7
s_add_u32 s73, s73, s61
s_add_u32 m0, s75, 81920
s_add_u32 s73, s73, 0
buffer_load_dwordx4 v8, s[4:7], s73 offen lds
buffer_load_dwordx4 v9, s[4:7], s73 offen offset:1024 lds
s_waitcnt vmcnt(6)
s_barrier
s_add_u32 s79, s68, 1
s_and_b32 s79, s79, 7
s_or_b32 s79, s79, 0
s_lshl_b32 s72, s79, 19
s_add_u32 s72, s72, s60
s_add_u32 m0, s75, 32768
s_add_u32 s72, s72, 0
buffer_load_dwordx4 v4, s[16:19], s72 offen lds
buffer_load_dwordx4 v5, s[16:19], s72 offen offset:1024 lds
s_add_u32 s79, s68, 1
s_and_b32 s79, s79, 7
s_or_b32 s79, s79, 0
s_lshl_b32 s72, s79, 19
s_add_u32 s72, s72, s60
s_add_u32 m0, s75, 40960
s_add_u32 s72, s72, 256
buffer_load_dwordx4 v4, s[16:19], s72 offen lds
buffer_load_dwordx4 v5, s[16:19], s72 offen offset:1024 lds
s_add_u32 s79, s68, 1
s_and_b32 s79, s79, 7
s_or_b32 s79, s79, 0
s_lshl_b32 s73, s79, 7
s_add_u32 s73, s73, s61
s_add_u32 m0, s75, 90112
s_add_u32 s73, s73, 131072
buffer_load_dwordx4 v8, s[4:7], s73 offen lds
buffer_load_dwordx4 v9, s[4:7], s73 offen offset:1024 lds
s_waitcnt vmcnt(6)
s_barrier
s_add_u32 s79, s68, 1
s_and_b32 s79, s79, 7
s_or_b32 s79, s79, 0
s_lshl_b32 s72, s79, 19
s_add_u32 s72, s72, s60
s_add_u32 m0, s75, 49152
s_add_u32 s72, s72, 262144
buffer_load_dwordx4 v4, s[16:19], s72 offen lds
buffer_load_dwordx4 v5, s[16:19], s72 offen offset:1024 lds
s_add_u32 s79, s68, 1
s_and_b32 s79, s79, 7
s_or_b32 s79, s79, 0
s_lshl_b32 s72, s79, 19
s_add_u32 s72, s72, s60
s_add_u32 m0, s75, 57344
s_add_u32 s72, s72, 262400
buffer_load_dwordx4 v4, s[16:19], s72 offen lds
buffer_load_dwordx4 v5, s[16:19], s72 offen offset:1024 lds
s_add_u32 s79, s68, 2
s_and_b32 s79, s79, 7
s_or_b32 s79, s79, 0
s_lshl_b32 s73, s79, 7
s_add_u32 s73, s73, s61
s_add_u32 m0, s75, 98304
s_add_u32 s73, s73, 0
buffer_load_dwordx4 v8, s[4:7], s73 offen lds
buffer_load_dwordx4 v9, s[4:7], s73 offen offset:1024 lds
s_waitcnt vmcnt(6)
s_barrier
s_add_u32 s79, s68, 2
s_and_b32 s79, s79, 7
s_or_b32 s79, s79, 0
s_lshl_b32 s72, s79, 19
s_add_u32 s72, s72, s60
s_add_u32 m0, s75, 0
s_add_u32 s72, s72, 0
buffer_load_dwordx4 v4, s[16:19], s72 offen lds
buffer_load_dwordx4 v5, s[16:19], s72 offen offset:1024 lds
s_add_u32 s79, s68, 2
s_and_b32 s79, s79, 7
s_or_b32 s79, s79, 0
s_lshl_b32 s72, s79, 19
s_add_u32 s72, s72, s60
s_add_u32 m0, s75, 8192
s_add_u32 s72, s72, 256
buffer_load_dwordx4 v4, s[16:19], s72 offen lds
buffer_load_dwordx4 v5, s[16:19], s72 offen offset:1024 lds
s_add_u32 s79, s68, 2
s_and_b32 s79, s79, 7
s_or_b32 s79, s79, 0
s_lshl_b32 s73, s79, 7
s_add_u32 s73, s73, s61
s_add_u32 m0, s75, 106496
s_add_u32 s73, s73, 131072
buffer_load_dwordx4 v8, s[4:7], s73 offen lds
buffer_load_dwordx4 v9, s[4:7], s73 offen offset:1024 lds
s_cmp_lg_u32 s62, 0
s_cbranch_scc1 vs1
s_add_u32 s72, s76, 0
buffer_load_dwordx4 v[32:35], v3, s[12:15], s72 offen offset:0 nt
buffer_load_dwordx4 v[36:39], v3, s[12:15], s72 offen offset:1024 nt
buffer_load_dwordx4 v[40:43], v3, s[12:15], s72 offen offset:2048 nt
buffer_load_dwordx4 v[44:47], v3, s[12:15], s72 offen offset:3072 nt
s_add_u32 s72, s76, 16384
buffer_load_dwordx4 v[48:51], v3, s[12:15], s72 offen offset:0 nt
buffer_load_dwordx4 v[52:55], v3, s[12:15], s72 offen offset:1024 nt
buffer_load_dwordx4 v[56:59], v3, s[12:15], s72 offen offset:2048 nt
buffer_load_dwordx4 v[60:63], v3, s[12:15], s72 offen offset:3072 nt
s_waitcnt vmcnt(14)
s_branch vb1
vs1:
s_waitcnt vmcnt(6)
vb1:
s_barrier
s_add_u32 s79, s68, 2
s_and_b32 s79, s79, 7
s_or_b32 s79, s79, 0
s_lshl_b32 s72, s79, 19
s_add_u32 s72, s72, s60
s_add_u32 m0, s75, 16384
s_add_u32 s72, s72, 262144
buffer_load_dwordx4 v4, s[16:19], s72 offen lds
buffer_load_dwordx4 v5, s[16:19], s72 offen offset:1024 lds
s_add_u32 s79, s68, 2
s_and_b32 s79, s79, 7
s_or_b32 s79, s79, 0
s_lshl_b32 s72, s79, 19
s_add_u32 s72, s72, s60
s_add_u32 m0, s75, 24576
s_add_u32 s72, s72, 262400
buffer_load_dwordx4 v4, s[16:19], s72 offen lds
buffer_load_dwordx4 v5, s[16:19], s72 offen offset:1024 lds
s_add_u32 s79, s68, 3
s_and_b32 s79, s79, 7
s_or_b32 s79, s79, 0
s_lshl_b32 s73, s79, 7
s_add_u32 s73, s73, s61
s_add_u32 m0, s75, 114688
s_add_u32 s73, s73, 0
buffer_load_dwordx4 v8, s[4:7], s73 offen lds
buffer_load_dwordx4 v9, s[4:7], s73 offen offset:1024 lds
s_cmp_lg_u32 s62, 1
s_cbranch_scc1 vs2
s_add_u32 s72, s76, 0
buffer_load_dwordx4 v[32:35], v3, s[12:15], s72 offen offset:0 nt
buffer_load_dwordx4 v[36:39], v3, s[12:15], s72 offen offset:1024 nt
buffer_load_dwordx4 v[40:43], v3, s[12:15], s72 offen offset:2048 nt
buffer_load_dwordx4 v[44:47], v3, s[12:15], s72 offen offset:3072 nt
s_add_u32 s72, s76, 16384
buffer_load_dwordx4 v[48:51], v3, s[12:15], s72 offen offset:0 nt
buffer_load_dwordx4 v[52:55], v3, s[12:15], s72 offen offset:1024 nt
buffer_load_dwordx4 v[56:59], v3, s[12:15], s72 offen offset:2048 nt
buffer_load_dwordx4 v[60:63], v3, s[12:15], s72 offen offset:3072 nt
s_waitcnt vmcnt(14)
s_branch vb2
vs2:
s_waitcnt vmcnt(6)
vb2:
s_barrier
s_add_u32 s79, s68, 3
s_and_b32 s79, s79, 7
s_or_b32 s79, s79, 0
s_lshl_b32 s72, s79, 19
s_add_u32 s72, s72, s60
s_add_u32 m0, s75, 32768
s_add_u32 s72, s72, 0
buffer_load_dwordx4 v4, s[16:19], s72 offen lds
buffer_load_dwordx4 v5, s[16:19], s72 offen offset:1024 lds
s_add_u32 s79, s68, 3
s_and_b32 s79, s79, 7
s_or_b32 s79, s79, 0
s_lshl_b32 s72, s79, 19
s_add_u32 s72, s72, s60
s_add_u32 m0, s75, 40960
s_add_u32 s72, s72, 256
buffer_load_dwordx4 v4, s[16:19], s72 offen lds
buffer_load_dwordx4 v5, s[16:19], s72 offen offset:1024 lds
s_add_u32 s79, s68, 3
s_and_b32 s79, s79, 7
s_or_b32 s79, s79, 0
s_lshl_b32 s73, s79, 7
s_add_u32 s73, s73, s61
s_add_u32 m0, s75, 122880
s_add_u32 s73, s73, 131072
buffer_load_dwordx4 v8, s[4:7], s73 offen lds
buffer_load_dwordx4 v9, s[4:7], s73 offen offset:1024 lds
s_cmp_lg_u32 s62, 2
s_cbranch_scc1 vs3
s_add_u32 s72, s76, 0
buffer_load_dwordx4 v[32:35], v3, s[12:15], s72 offen offset:0 nt
buffer_load_dwordx4 v[36:39], v3, s[12:15], s72 offen offset:1024 nt
buffer_load_dwordx4 v[40:43], v3, s[12:15], s72 offen offset:2048 nt
buffer_load_dwordx4 v[44:47], v3, s[12:15], s72 offen offset:3072 nt
s_add_u32 s72, s76, 16384
buffer_load_dwordx4 v[48:51], v3, s[12:15], s72 offen offset:0 nt
buffer_load_dwordx4 v[52:55], v3, s[12:15], s72 offen offset:1024 nt
buffer_load_dwordx4 v[56:59], v3, s[12:15], s72 offen offset:2048 nt
buffer_load_dwordx4 v[60:63], v3, s[12:15], s72 offen offset:3072 nt
s_waitcnt vmcnt(14)
s_branch vb3
vs3:
s_waitcnt vmcnt(6)
vb3:
s_barrier
s_add_u32 s79, s68, 3
s_and_b32 s79, s79, 7
s_or_b32 s79, s79, 0
s_lshl_b32 s72, s79, 19
s_add_u32 s72, s72, s60
s_add_u32 m0, s75, 49152
s_add_u32 s72, s72, 262144
buffer_load_dwordx4 v4, s[16:19], s72 offen lds
buffer_load_dwordx4 v5, s[16:19], s72 offen offset:1024 lds
s_add_u32 s79, s68, 3
s_and_b32 s79, s79, 7
s_or_b32 s79, s79, 0
s_lshl_b32 s72, s79, 19
s_add_u32 s72, s72, s60
s_add_u32 m0, s75, 57344
s_add_u32 s72, s72, 262400
buffer_load_dwordx4 v4, s[16:19], s72 offen lds
buffer_load_dwordx4 v5, s[16:19], s72 offen offset:1024 lds
s_add_u32 s79, s68, 4
s_and_b32 s79, s79, 7
s_or_b32 s79, s79, 0
s_lshl_b32 s73, s79, 7
s_add_u32 s73, s73, s61
s_add_u32 m0, s75, 65536
s_add_u32 s73, s73, 0
buffer_load_dwordx4 v8, s[4:7], s73 offen lds
buffer_load_dwordx4 v9, s[4:7], s73 offen offset:1024 lds
s_cmp_lg_u32 s62, 3
s_cbranch_scc1 vs4
s_add_u32 s72, s76, 0
buffer_load_dwordx4 v[32:35], v3, s[12:15], s72 offen offset:0 nt
buffer_load_dwordx4 v[36:39], v3, s[12:15], s72 offen offset:1024 nt
buffer_load_dwordx4 v[40:43], v3, s[12:15], s72 offen offset:2048 nt
buffer_load_dwordx4 v[44:47], v3, s[12:15], s72 offen offset:3072 nt
s_add_u32 s72, s76, 16384
buffer_load_dwordx4 v[48:51], v3, s[12:15], s72 offen offset:0 nt
buffer_load_dwordx4 v[52:55], v3, s[12:15], s72 offen offset:1024 nt
buffer_load_dwordx4 v[56:59], v3, s[12:15], s72 offen offset:2048 nt
buffer_load_dwordx4 v[60:63], v3, s[12:15], s72 offen offset:3072 nt
s_waitcnt vmcnt(14)
s_branch vb4
vs4:
s_waitcnt vmcnt(6)
vb4:
s_barrier
s_add_u32 s79, s68, 4
s_and_b32 s79, s79, 7
s_or_b32 s79, s79, 0
s_lshl_b32 s72, s79, 19
s_add_u32 s72, s72, s60
s_add_u32 m0, s75, 0
s_add_u32 s72, s72, 0
buffer_load_dwordx4 v4, s[16:19], s72 offen lds
buffer_load_dwordx4 v5, s[16:19], s72 offen offset:1024 lds
s_add_u32 s79, s68, 4
s_and_b32 s79, s79, 7
s_or_b32 s79, s79, 0
s_lshl_b32 s72, s79, 19
s_add_u32 s72, s72, s60
s_add_u32 m0, s75, 8192
s_add_u32 s72, s72, 256
buffer_load_dwordx4 v4, s[16:19], s72 offen lds
buffer_load_dwordx4 v5, s[16:19], s72 offen offset:1024 lds
s_add_u32 s79, s68, 4
s_and_b32 s79, s79, 7
s_or_b32 s79, s79, 0
s_lshl_b32 s73, s79, 7
s_add_u32 s73, s73, s61
s_add_u32 m0, s75, 73728
s_add_u32 s73, s73, 131072
buffer_load_dwordx4 v8, s[4:7], s73 offen lds
buffer_load_dwordx4 v9, s[4:7], s73 offen offset:1024 lds
s_cmp_lg_u32 s62, 0
s_cbranch_scc1 vs5
s_add_u32 s72, s76, 32768
buffer_load_dwordx4 v[64:67], v3, s[12:15], s72 offen offset:0 nt
buffer_load_dwordx4 v[68:71], v3, s[12:15], s72 offen offset:1024 nt
buffer_load_dwordx4 v[72:75], v3, s[12:15], s72 offen offset:2048 nt
buffer_load_dwordx4 v[76:79], v3, s[12:15], s72 offen offset:3072 nt
s_add_u32 s72, s76, 49152
buffer_load_dwordx4 v[80:83], v3, s[12:15], s72 offen offset:0 nt
buffer_load_dwordx4 v[84:87], v3, s[12:15], s72 offen offset:1024 nt
buffer_load_dwordx4 v[88:91], v3, s[12:15], s72 offen offset:2048 nt
buffer_load_dwordx4 v[92:95], v3, s[12:15], s72 offen offset:3072 nt
s_waitcnt vmcnt(14)
s_branch vb5
vs5:
s_waitcnt vmcnt(6)
vb5:
s_barrier
s_add_u32 s79, s68, 4
s_and_b32 s79, s79, 7
s_or_b32 s79, s79, 0
s_lshl_b32 s72, s79, 19
s_add_u32 s72, s72, s60
s_add_u32 m0, s75, 16384
s_add_u32 s72, s72, 262144
buffer_load_dwordx4 v4, s[16:19], s72 offen lds
buffer_load_dwordx4 v5, s[16:19], s72 offen offset:1024 lds
s_add_u32 s79, s68, 4
s_and_b32 s79, s79, 7
s_or_b32 s79, s79, 0
s_lshl_b32 s72, s79, 19
s_add_u32 s72, s72, s60
s_add_u32 m0, s75, 24576
s_add_u32 s72, s72, 262400
buffer_load_dwordx4 v4, s[16:19], s72 offen lds
buffer_load_dwordx4 v5, s[16:19], s72 offen offset:1024 lds
s_add_u32 s79, s68, 5
s_and_b32 s79, s79, 7
s_or_b32 s79, s79, 0
s_lshl_b32 s73, s79, 7
s_add_u32 s73, s73, s61
s_add_u32 m0, s75, 81920
s_add_u32 s73, s73, 0
buffer_load_dwordx4 v8, s[4:7], s73 offen lds
buffer_load_dwordx4 v9, s[4:7], s73 offen offset:1024 lds
s_cmp_lg_u32 s62, 1
s_cbranch_scc1 vs6
s_add_u32 s72, s76, 32768
buffer_load_dwordx4 v[64:67], v3, s[12:15], s72 offen offset:0 nt
buffer_load_dwordx4 v[68:71], v3, s[12:15], s72 offen offset:1024 nt
buffer_load_dwordx4 v[72:75], v3, s[12:15], s72 offen offset:2048 nt
buffer_load_dwordx4 v[76:79], v3, s[12:15], s72 offen offset:3072 nt
s_add_u32 s72, s76, 49152
buffer_load_dwordx4 v[80:83], v3, s[12:15], s72 offen offset:0 nt
buffer_load_dwordx4 v[84:87], v3, s[12:15], s72 offen offset:1024 nt
buffer_load_dwordx4 v[88:91], v3, s[12:15], s72 offen offset:2048 nt
buffer_load_dwordx4 v[92:95], v3, s[12:15], s72 offen offset:3072 nt
s_waitcnt vmcnt(14)
s_branch vb6
vs6:
s_waitcnt vmcnt(6)
vb6:
s_barrier
s_add_u32 s79, s68, 5
s_and_b32 s79, s79, 7
s_or_b32 s79, s79, 0
s_lshl_b32 s72, s79, 19
s_add_u32 s72, s72, s60
s_add_u32 m0, s75, 32768
s_add_u32 s72, s72, 0
buffer_load_dwordx4 v4, s[16:19], s72 offen lds
buffer_load_dwordx4 v5, s[16:19], s72 offen offset:1024 lds
s_add_u32 s79, s68, 5
s_and_b32 s79, s79, 7
s_or_b32 s79, s79, 0
s_lshl_b32 s72, s79, 19
s_add_u32 s72, s72, s60
s_add_u32 m0, s75, 40960
s_add_u32 s72, s72, 256
buffer_load_dwordx4 v4, s[16:19], s72 offen lds
buffer_load_dwordx4 v5, s[16:19], s72 offen offset:1024 lds
s_add_u32 s79, s68, 5
s_and_b32 s79, s79, 7
s_or_b32 s79, s79, 0
s_lshl_b32 s73, s79, 7
s_add_u32 s73, s73, s61
s_add_u32 m0, s75, 90112
s_add_u32 s73, s73, 131072
buffer_load_dwordx4 v8, s[4:7], s73 offen lds
buffer_load_dwordx4 v9, s[4:7], s73 offen offset:1024 lds
s_cmp_lg_u32 s62, 2
s_cbranch_scc1 vs7
s_add_u32 s72, s76, 32768
buffer_load_dwordx4 v[64:67], v3, s[12:15], s72 offen offset:0 nt
buffer_load_dwordx4 v[68:71], v3, s[12:15], s72 offen offset:1024 nt
buffer_load_dwordx4 v[72:75], v3, s[12:15], s72 offen offset:2048 nt
buffer_load_dwordx4 v[76:79], v3, s[12:15], s72 offen offset:3072 nt
s_add_u32 s72, s76, 49152
buffer_load_dwordx4 v[80:83], v3, s[12:15], s72 offen offset:0 nt
buffer_load_dwordx4 v[84:87], v3, s[12:15], s72 offen offset:1024 nt
buffer_load_dwordx4 v[88:91], v3, s[12:15], s72 offen offset:2048 nt
buffer_load_dwordx4 v[92:95], v3, s[12:15], s72 offen offset:3072 nt
s_waitcnt vmcnt(14)
s_branch vb7
vs7:
s_waitcnt vmcnt(6)
vb7:
s_barrier
s_add_u32 s79, s68, 5
s_and_b32 s79, s79, 7
s_or_b32 s79, s79, 0
s_lshl_b32 s72, s79, 19
s_add_u32 s72, s72, s60
s_add_u32 m0, s75, 49152
s_add_u32 s72, s72, 262144
buffer_load_dwordx4 v4, s[16:19], s72 offen lds
buffer_load_dwordx4 v5, s[16:19], s72 offen offset:1024 lds
s_add_u32 s79, s68, 5
s_and_b32 s79, s79, 7
s_or_b32 s79, s79, 0
s_lshl_b32 s72, s79, 19
s_add_u32 s72, s72, s60
s_add_u32 m0, s75, 57344
s_add_u32 s72, s72, 262400
buffer_load_dwordx4 v4, s[16:19], s72 offen lds
buffer_load_dwordx4 v5, s[16:19], s72 offen offset:1024 lds
s_add_u32 s79, s68, 6
s_and_b32 s79, s79, 7
s_or_b32 s79, s79, 0
s_lshl_b32 s73, s79, 7
s_add_u32 s73, s73, s61
s_add_u32 m0, s75, 98304
s_add_u32 s73, s73, 0
buffer_load_dwordx4 v8, s[4:7], s73 offen lds
buffer_load_dwordx4 v9, s[4:7], s73 offen offset:1024 lds
s_cmp_lg_u32 s62, 3
s_cbranch_scc1 vs8
s_add_u32 s72, s76, 32768
buffer_load_dwordx4 v[64:67], v3, s[12:15], s72 offen offset:0 nt
buffer_load_dwordx4 v[68:71], v3, s[12:15], s72 offen offset:1024 nt
buffer_load_dwordx4 v[72:75], v3, s[12:15], s72 offen offset:2048 nt
buffer_load_dwordx4 v[76:79], v3, s[12:15], s72 offen offset:3072 nt
s_add_u32 s72, s76, 49152
buffer_load_dwordx4 v[80:83], v3, s[12:15], s72 offen offset:0 nt
buffer_load_dwordx4 v[84:87], v3, s[12:15], s72 offen offset:1024 nt
buffer_load_dwordx4 v[88:91], v3, s[12:15], s72 offen offset:2048 nt
buffer_load_dwordx4 v[92:95], v3, s[12:15], s72 offen offset:3072 nt
s_waitcnt vmcnt(14)
s_branch vb8
vs8:
s_waitcnt vmcnt(6)
vb8:
s_barrier
s_add_u32 s79, s68, 6
s_and_b32 s79, s79, 7
s_or_b32 s79, s79, 0
s_lshl_b32 s72, s79, 19
s_add_u32 s72, s72, s60
s_add_u32 m0, s75, 0
s_add_u32 s72, s72, 0
buffer_load_dwordx4 v4, s[16:19], s72 offen lds
buffer_load_dwordx4 v5, s[16:19], s72 offen offset:1024 lds
s_add_u32 s79, s68, 6
s_and_b32 s79, s79, 7
s_or_b32 s79, s79, 0
s_lshl_b32 s72, s79, 19
s_add_u32 s72, s72, s60
s_add_u32 m0, s75, 8192
s_add_u32 s72, s72, 256
buffer_load_dwordx4 v4, s[16:19], s72 offen lds
buffer_load_dwordx4 v5, s[16:19], s72 offen offset:1024 lds
s_add_u32 s79, s68, 6
s_and_b32 s79, s79, 7
s_or_b32 s79, s79, 0
s_lshl_b32 s73, s79, 7
s_add_u32 s73, s73, s61
s_add_u32 m0, s75, 106496
s_add_u32 s73, s73, 131072
buffer_load_dwordx4 v8, s[4:7], s73 offen lds
buffer_load_dwordx4 v9, s[4:7], s73 offen offset:1024 lds
s_waitcnt vmcnt(6)
s_barrier
s_add_u32 s79, s68, 6
s_and_b32 s79, s79, 7
s_or_b32 s79, s79, 0
s_lshl_b32 s72, s79, 19
s_add_u32 s72, s72, s60
s_add_u32 m0, s75, 16384
s_add_u32 s72, s72, 262144
buffer_load_dwordx4 v4, s[16:19], s72 offen lds
buffer_load_dwordx4 v5, s[16:19], s72 offen offset:1024 lds
s_add_u32 s79, s68, 6
s_and_b32 s79, s79, 7
s_or_b32 s79, s79, 0
s_lshl_b32 s72, s79, 19
s_add_u32 s72, s72, s60
s_add_u32 m0, s75, 24576
s_add_u32 s72, s72, 262400
buffer_load_dwordx4 v4, s[16:19], s72 offen lds
buffer_load_dwordx4 v5, s[16:19], s72 offen offset:1024 lds
s_add_u32 s79, s68, 7
s_and_b32 s79, s79, 7
s_or_b32 s79, s79, 0
s_lshl_b32 s73, s79, 7
s_add_u32 s73, s73, s61
s_add_u32 m0, s75, 114688
s_add_u32 s73, s73, 0
buffer_load_dwordx4 v8, s[4:7], s73 offen lds
buffer_load_dwordx4 v9, s[4:7], s73 offen offset:1024 lds
s_waitcnt vmcnt(6)
s_barrier
s_add_u32 s79, s68, 7
s_and_b32 s79, s79, 7
s_or_b32 s79, s79, 0
s_lshl_b32 s72, s79, 19
s_add_u32 s72, s72, s60
s_add_u32 m0, s75, 32768
s_add_u32 s72, s72, 0
buffer_load_dwordx4 v4, s[16:19], s72 offen lds
buffer_load_dwordx4 v5, s[16:19], s72 offen offset:1024 lds
s_add_u32 s79, s68, 7
s_and_b32 s79, s79, 7
s_or_b32 s79, s79, 0
s_lshl_b32 s72, s79, 19
s_add_u32 s72, s72, s60
s_add_u32 m0, s75, 40960
s_add_u32 s72, s72, 256
buffer_load_dwordx4 v4, s[16:19], s72 offen lds
buffer_load_dwordx4 v5, s[16:19], s72 offen offset:1024 lds
s_add_u32 s79, s68, 7
s_and_b32 s79, s79, 7
s_or_b32 s79, s79, 0
s_lshl_b32 s73, s79, 7
s_add_u32 s73, s73, s61
s_add_u32 m0, s75, 122880
s_add_u32 s73, s73, 131072
buffer_load_dwordx4 v8, s[4:7], s73 offen lds
buffer_load_dwordx4 v9, s[4:7], s73 offen offset:1024 lds
s_waitcnt vmcnt(6)
s_barrier
s_add_u32 s79, s68, 7
s_and_b32 s79, s79, 7
s_or_b32 s79, s79, 0
s_lshl_b32 s72, s79, 19
s_add_u32 s72, s72, s60
s_add_u32 m0, s75, 49152
s_add_u32 s72, s72, 262144
buffer_load_dwordx4 v4, s[16:19], s72 offen lds
buffer_load_dwordx4 v5, s[16:19], s72 offen offset:1024 lds
s_add_u32 s79, s68, 7
s_and_b32 s79, s79, 7
s_or_b32 s79, s79, 0
s_lshl_b32 s72, s79, 19
s_add_u32 s72, s72, s60
s_add_u32 m0, s75, 57344
s_add_u32 s72, s72, 262400
buffer_load_dwordx4 v4, s[16:19], s72 offen lds
buffer_load_dwordx4 v5, s[16:19], s72 offen offset:1024 lds
s_add_u32 s79, s68, 8
s_and_b32 s79, s79, 7
s_or_b32 s79, s79, 8
s_lshl_b32 s73, s79, 7
s_add_u32 s73, s73, s61
s_add_u32 m0, s75, 65536
s_add_u32 s73, s73, 0
buffer_load_dwordx4 v8, s[4:7], s73 offen lds
buffer_load_dwordx4 v9, s[4:7], s73 offen offset:1024 lds
s_waitcnt vmcnt(6)
s_barrier
s_add_u32 s79, s68, 8
s_and_b32 s79, s79, 7
s_or_b32 s79, s79, 8
s_lshl_b32 s72, s79, 19
s_add_u32 s72, s72, s60
s_add_u32 m0, s75, 0
s_add_u32 s72, s72, 0
buffer_load_dwordx4 v4, s[16:19], s72 offen lds
buffer_load_dwordx4 v5, s[16:19], s72 offen offset:1024 lds
s_add_u32 s79, s68, 8
s_and_b32 s79, s79, 7
s_or_b32 s79, s79, 8
s_lshl_b32 s72, s79, 19
s_add_u32 s72, s72, s60
s_add_u32 m0, s75, 8192
s_add_u32 s72, s72, 256
buffer_load_dwordx4 v4, s[16:19], s72 offen lds
buffer_load_dwordx4 v5, s[16:19], s72 offen offset:1024 lds
s_add_u32 s79, s68, 8
s_and_b32 s79, s79, 7
s_or_b32 s79, s79, 8
s_lshl_b32 s73, s79, 7
s_add_u32 s73, s73, s61
s_add_u32 m0, s75, 73728
s_add_u32 s73, s73, 131072
buffer_load_dwordx4 v8, s[4:7], s73 offen lds
buffer_load_dwordx4 v9, s[4:7], s73 offen offset:1024 lds
s_waitcnt vmcnt(6)
s_barrier
s_add_u32 s79, s68, 8
s_and_b32 s79, s79, 7
s_or_b32 s79, s79, 8
s_lshl_b32 s72, s79, 19
s_add_u32 s72, s72, s60
s_add_u32 m0, s75, 16384
s_add_u32 s72, s72, 262144
buffer_load_dwordx4 v4, s[16:19], s72 offen lds
buffer_load_dwordx4 v5, s[16:19], s72 offen offset:1024 lds
s_add_u32 s79, s68, 8
s_and_b32 s79, s79, 7
s_or_b32 s79, s79, 8
s_lshl_b32 s72, s79, 19
s_add_u32 s72, s72, s60
s_add_u32 m0, s75, 24576
s_add_u32 s72, s72, 262400
buffer_load_dwordx4 v4, s[16:19], s72 offen lds
buffer_load_dwordx4 v5, s[16:19], s72 offen offset:1024 lds
s_add_u32 s79, s68, 9
s_and_b32 s79, s79, 7
s_or_b32 s79, s79, 8
s_lshl_b32 s73, s79, 7
s_add_u32 s73, s73, s61
s_add_u32 m0, s75, 81920
s_add_u32 s73, s73, 0
buffer_load_dwordx4 v8, s[4:7], s73 offen lds
buffer_load_dwordx4 v9, s[4:7], s73 offen offset:1024 lds
s_waitcnt vmcnt(6)
s_barrier
s_add_u32 s79, s68, 9
s_and_b32 s79, s79, 7
s_or_b32 s79, s79, 8
s_lshl_b32 s72, s79, 19
s_add_u32 s72, s72, s60
s_add_u32 m0, s75, 32768
s_add_u32 s72, s72, 0
buffer_load_dwordx4 v4, s[16:19], s72 offen lds
buffer_load_dwordx4 v5, s[16:19], s72 offen offset:1024 lds
s_add_u32 s79, s68, 9
s_and_b32 s79, s79, 7
s_or_b32 s79, s79, 8
s_lshl_b32 s72, s79, 19
s_add_u32 s72, s72, s60
s_add_u32 m0, s75, 40960
s_add_u32 s72, s72, 256
buffer_load_dwordx4 v4, s[16:19], s72 offen lds
buffer_load_dwordx4 v5, s[16:19], s72 offen offset:1024 lds
s_add_u32 s79, s68, 9
s_and_b32 s79, s79, 7
s_or_b32 s79, s79, 8
s_lshl_b32 s73, s79, 7
s_add_u32 s73, s73, s61
s_add_u32 m0, s75, 90112
s_add_u32 s73, s73, 131072
buffer_load_dwordx4 v8, s[4:7], s73 offen lds
buffer_load_dwordx4 v9, s[4:7], s73 offen offset:1024 lds
s_waitcnt vmcnt(6)
s_barrier
s_add_u32 s79, s68, 9
s_and_b32 s79, s79, 7
s_or_b32 s79, s79, 8
s_lshl_b32 s72, s79, 19
s_add_u32 s72, s72, s60
s_add_u32 m0, s75, 49152
s_add_u32 s72, s72, 262144
buffer_load_dwordx4 v4, s[16:19], s72 offen lds
buffer_load_dwordx4 v5, s[16:19], s72 offen offset:1024 lds
s_add_u32 s79, s68, 9
s_and_b32 s79, s79, 7
s_or_b32 s79, s79, 8
s_lshl_b32 s72, s79, 19
s_add_u32 s72, s72, s60
s_add_u32 m0, s75, 57344
s_add_u32 s72, s72, 262400
buffer_load_dwordx4 v4, s[16:19], s72 offen lds
buffer_load_dwordx4 v5, s[16:19], s72 offen offset:1024 lds
s_add_u32 s79, s68, 10
s_and_b32 s79, s79, 7
s_or_b32 s79, s79, 8
s_lshl_b32 s73, s79, 7
s_add_u32 s73, s73, s61
s_add_u32 m0, s75, 98304
s_add_u32 s73, s73, 0
buffer_load_dwordx4 v8, s[4:7], s73 offen lds
buffer_load_dwordx4 v9, s[4:7], s73 offen offset:1024 lds
s_waitcnt vmcnt(6)
s_barrier
s_add_u32 s79, s68, 10
s_and_b32 s79, s79, 7
s_or_b32 s79, s79, 8
s_lshl_b32 s72, s79, 19
s_add_u32 s72, s72, s60
s_add_u32 m0, s75, 0
s_add_u32 s72, s72, 0
buffer_load_dwordx4 v4, s[16:19], s72 offen lds
buffer_load_dwordx4 v5, s[16:19], s72 offen offset:1024 lds
s_add_u32 s79, s68, 10
s_and_b32 s79, s79, 7
s_or_b32 s79, s79, 8
s_lshl_b32 s72, s79, 19
s_add_u32 s72, s72, s60
s_add_u32 m0, s75, 8192
s_add_u32 s72, s72, 256
buffer_load_dwordx4 v4, s[16:19], s72 offen lds
buffer_load_dwordx4 v5, s[16:19], s72 offen offset:1024 lds
s_add_u32 s79, s68, 10
s_and_b32 s79, s79, 7
s_or_b32 s79, s79, 8
s_lshl_b32 s73, s79, 7
s_add_u32 s73, s73, s61
s_add_u32 m0, s75, 106496
s_add_u32 s73, s73, 131072
buffer_load_dwordx4 v8, s[4:7], s73 offen lds
buffer_load_dwordx4 v9, s[4:7], s73 offen offset:1024 lds
s_cmp_lg_u32 s62, 0
s_cbranch_scc1 vs9
s_add_u32 s72, s76, 65536
buffer_load_dwordx4 v[96:99], v3, s[12:15], s72 offen offset:0 nt
buffer_load_dwordx4 v[100:103], v3, s[12:15], s72 offen offset:1024 nt
buffer_load_dwordx4 v[104:107], v3, s[12:15], s72 offen offset:2048 nt
buffer_load_dwordx4 v[108:111], v3, s[12:15], s72 offen offset:3072 nt
s_add_u32 s72, s76, 81920
buffer_load_dwordx4 v[112:115], v3, s[12:15], s72 offen offset:0 nt
buffer_load_dwordx4 v[116:119], v3, s[12:15], s72 offen offset:1024 nt
buffer_load_dwordx4 v[120:123], v3, s[12:15], s72 offen offset:2048 nt
buffer_load_dwordx4 v[124:127], v3, s[12:15], s72 offen offset:3072 nt
s_waitcnt vmcnt(14)
s_branch vb9
vs9:
s_waitcnt vmcnt(6)
vb9:
s_barrier
s_add_u32 s79, s68, 10
s_and_b32 s79, s79, 7
s_or_b32 s79, s79, 8
s_lshl_b32 s72, s79, 19
s_add_u32 s72, s72, s60
s_add_u32 m0, s75, 16384
s_add_u32 s72, s72, 262144
buffer_load_dwordx4 v4, s[16:19], s72 offen lds
buffer_load_dwordx4 v5, s[16:19], s72 offen offset:1024 lds
s_add_u32 s79, s68, 10
s_and_b32 s79, s79, 7
s_or_b32 s79, s79, 8
s_lshl_b32 s72, s79, 19
s_add_u32 s72, s72, s60
s_add_u32 m0, s75, 24576
s_add_u32 s72, s72, 262400
buffer_load_dwordx4 v4, s[16:19], s72 offen lds
buffer_load_dwordx4 v5, s[16:19], s72 offen offset:1024 lds
s_add_u32 s79, s68, 11
s_and_b32 s79, s79, 7
s_or_b32 s79, s79, 8
s_lshl_b32 s73, s79, 7
s_add_u32 s73, s73, s61
s_add_u32 m0, s75, 114688
s_add_u32 s73, s73, 0
buffer_load_dwordx4 v8, s[4:7], s73 offen lds
buffer_load_dwordx4 v9, s[4:7], s73 offen offset:1024 lds
s_cmp_lg_u32 s62, 1
s_cbranch_scc1 vs10
s_add_u32 s72, s76, 65536
buffer_load_dwordx4 v[96:99], v3, s[12:15], s72 offen offset:0 nt
buffer_load_dwordx4 v[100:103], v3, s[12:15], s72 offen offset:1024 nt
buffer_load_dwordx4 v[104:107], v3, s[12:15], s72 offen offset:2048 nt
buffer_load_dwordx4 v[108:111], v3, s[12:15], s72 offen offset:3072 nt
s_add_u32 s72, s76, 81920
buffer_load_dwordx4 v[112:115], v3, s[12:15], s72 offen offset:0 nt
buffer_load_dwordx4 v[116:119], v3, s[12:15], s72 offen offset:1024 nt
buffer_load_dwordx4 v[120:123], v3, s[12:15], s72 offen offset:2048 nt
buffer_load_dwordx4 v[124:127], v3, s[12:15], s72 offen offset:3072 nt
s_waitcnt vmcnt(14)
s_branch vb10
vs10:
s_waitcnt vmcnt(6)
vb10:
s_barrier
s_add_u32 s79, s68, 11
s_and_b32 s79, s79, 7
s_or_b32 s79, s79, 8
s_lshl_b32 s72, s79, 19
s_add_u32 s72, s72, s60
s_add_u32 m0, s75, 32768
s_add_u32 s72, s72, 0
buffer_load_dwordx4 v4, s[16:19], s72 offen lds
buffer_load_dwordx4 v5, s[16:19], s72 offen offset:1024 lds
s_add_u32 s79, s68, 11
s_and_b32 s79, s79, 7
s_or_b32 s79, s79, 8
s_lshl_b32 s72, s79, 19
s_add_u32 s72, s72, s60
s_add_u32 m0, s75, 40960
s_add_u32 s72, s72, 256
buffer_load_dwordx4 v4, s[16:19], s72 offen lds
buffer_load_dwordx4 v5, s[16:19], s72 offen offset:1024 lds
s_add_u32 s79, s68, 11
s_and_b32 s79, s79, 7
s_or_b32 s79, s79, 8
s_lshl_b32 s73, s79, 7
s_add_u32 s73, s73, s61
s_add_u32 m0, s75, 122880
s_add_u32 s73, s73, 131072
buffer_load_dwordx4 v8, s[4:7], s73 offen lds
buffer_load_dwordx4 v9, s[4:7], s73 offen offset:1024 lds
s_cmp_lg_u32 s62, 2
s_cbranch_scc1 vs11
s_add_u32 s72, s76, 65536
buffer_load_dwordx4 v[96:99], v3, s[12:15], s72 offen offset:0 nt
buffer_load_dwordx4 v[100:103], v3, s[12:15], s72 offen offset:1024 nt
buffer_load_dwordx4 v[104:107], v3, s[12:15], s72 offen offset:2048 nt
buffer_load_dwordx4 v[108:111], v3, s[12:15], s72 offen offset:3072 nt
s_add_u32 s72, s76, 81920
buffer_load_dwordx4 v[112:115], v3, s[12:15], s72 offen offset:0 nt
buffer_load_dwordx4 v[116:119], v3, s[12:15], s72 offen offset:1024 nt
buffer_load_dwordx4 v[120:123], v3, s[12:15], s72 offen offset:2048 nt
buffer_load_dwordx4 v[124:127], v3, s[12:15], s72 offen offset:3072 nt
s_waitcnt vmcnt(14)
s_branch vb11
vs11:
s_waitcnt vmcnt(6)
vb11:
s_barrier
s_add_u32 s79, s68, 11
s_and_b32 s79, s79, 7
s_or_b32 s79, s79, 8
s_lshl_b32 s72, s79, 19
s_add_u32 s72, s72, s60
s_add_u32 m0, s75, 49152
s_add_u32 s72, s72, 262144
buffer_load_dwordx4 v4, s[16:19], s72 offen lds
buffer_load_dwordx4 v5, s[16:19], s72 offen offset:1024 lds
s_add_u32 s79, s68, 11
s_and_b32 s79, s79, 7
s_or_b32 s79, s79, 8
s_lshl_b32 s72, s79, 19
s_add_u32 s72, s72, s60
s_add_u32 m0, s75, 57344
s_add_u32 s72, s72, 262400
buffer_load_dwordx4 v4, s[16:19], s72 offen lds
buffer_load_dwordx4 v5, s[16:19], s72 offen offset:1024 lds
s_add_u32 s79, s68, 12
s_and_b32 s79, s79, 7
s_or_b32 s79, s79, 8
s_lshl_b32 s73, s79, 7
s_add_u32 s73, s73, s61
s_add_u32 m0, s75, 65536
s_add_u32 s73, s73, 0
buffer_load_dwordx4 v8, s[4:7], s73 offen lds
buffer_load_dwordx4 v9, s[4:7], s73 offen offset:1024 lds
s_cmp_lg_u32 s62, 3
s_cbranch_scc1 vs12
s_add_u32 s72, s76, 65536
buffer_load_dwordx4 v[96:99], v3, s[12:15], s72 offen offset:0 nt
buffer_load_dwordx4 v[100:103], v3, s[12:15], s72 offen offset:1024 nt
buffer_load_dwordx4 v[104:107], v3, s[12:15], s72 offen offset:2048 nt
buffer_load_dwordx4 v[108:111], v3, s[12:15], s72 offen offset:3072 nt
s_add_u32 s72, s76, 81920
buffer_load_dwordx4 v[112:115], v3, s[12:15], s72 offen offset:0 nt
buffer_load_dwordx4 v[116:119], v3, s[12:15], s72 offen offset:1024 nt
buffer_load_dwordx4 v[120:123], v3, s[12:15], s72 offen offset:2048 nt
buffer_load_dwordx4 v[124:127], v3, s[12:15], s72 offen offset:3072 nt
s_waitcnt vmcnt(14)
s_branch vb12
vs12:
s_waitcnt vmcnt(6)
vb12:
s_barrier
s_add_u32 s79, s68, 12
s_and_b32 s79, s79, 7
s_or_b32 s79, s79, 8
s_lshl_b32 s72, s79, 19
s_add_u32 s72, s72, s60
s_add_u32 m0, s75, 0
s_add_u32 s72, s72, 0
buffer_load_dwordx4 v4, s[16:19], s72 offen lds
buffer_load_dwordx4 v5, s[16:19], s72 offen offset:1024 lds
s_add_u32 s79, s68, 12
s_and_b32 s79, s79, 7
s_or_b32 s79, s79, 8
s_lshl_b32 s72, s79, 19
s_add_u32 s72, s72, s60
s_add_u32 m0, s75, 8192
s_add_u32 s72, s72, 256
buffer_load_dwordx4 v4, s[16:19], s72 offen lds
buffer_load_dwordx4 v5, s[16:19], s72 offen offset:1024 lds
s_add_u32 s79, s68, 12
s_and_b32 s79, s79, 7
s_or_b32 s79, s79, 8
s_lshl_b32 s73, s79, 7
s_add_u32 s73, s73, s61
s_add_u32 m0, s75, 73728
s_add_u32 s73, s73, 131072
buffer_load_dwordx4 v8, s[4:7], s73 offen lds
buffer_load_dwordx4 v9, s[4:7], s73 offen offset:1024 lds
s_cmp_lg_u32 s62, 0
s_cbranch_scc1 vs13
s_add_u32 s72, s76, 98304
buffer_load_dwordx4 v[128:131], v3, s[12:15], s72 offen offset:0 nt
buffer_load_dwordx4 v[132:135], v3, s[12:15], s72 offen offset:1024 nt
buffer_load_dwordx4 v[136:139], v3, s[12:15], s72 offen offset:2048 nt
buffer_load_dwordx4 v[140:143], v3, s[12:15], s72 offen offset:3072 nt
s_add_u32 s72, s76, 114688
buffer_load_dwordx4 v[144:147], v3, s[12:15], s72 offen offset:0 nt
buffer_load_dwordx4 v[148:151], v3, s[12:15], s72 offen offset:1024 nt
buffer_load_dwordx4 v[152:155], v3, s[12:15], s72 offen offset:2048 nt
buffer_load_dwordx4 v[156:159], v3, s[12:15], s72 offen offset:3072 nt
s_waitcnt vmcnt(14)
s_branch vb13
vs13:
s_waitcnt vmcnt(6)
vb13:
s_barrier
s_add_u32 s79, s68, 12
s_and_b32 s79, s79, 7
s_or_b32 s79, s79, 8
s_lshl_b32 s72, s79, 19
s_add_u32 s72, s72, s60
s_add_u32 m0, s75, 16384
s_add_u32 s72, s72, 262144
buffer_load_dwordx4 v4, s[16:19], s72 offen lds
buffer_load_dwordx4 v5, s[16:19], s72 offen offset:1024 lds
s_add_u32 s79, s68, 12
s_and_b32 s79, s79, 7
s_or_b32 s79, s79, 8
s_lshl_b32 s72, s79, 19
s_add_u32 s72, s72, s60
s_add_u32 m0, s75, 24576
s_add_u32 s72, s72, 262400
buffer_load_dwordx4 v4, s[16:19], s72 offen lds
buffer_load_dwordx4 v5, s[16:19], s72 offen offset:1024 lds
s_add_u32 s79, s68, 13
s_and_b32 s79, s79, 7
s_or_b32 s79, s79, 8
s_lshl_b32 s73, s79, 7
s_add_u32 s73, s73, s61
s_add_u32 m0, s75, 81920
s_add_u32 s73, s73, 0
buffer_load_dwordx4 v8, s[4:7], s73 offen lds
buffer_load_dwordx4 v9, s[4:7], s73 offen offset:1024 lds
s_cmp_lg_u32 s62, 1
s_cbranch_scc1 vs14
s_add_u32 s72, s76, 98304
buffer_load_dwordx4 v[128:131], v3, s[12:15], s72 offen offset:0 nt
buffer_load_dwordx4 v[132:135], v3, s[12:15], s72 offen offset:1024 nt
buffer_load_dwordx4 v[136:139], v3, s[12:15], s72 offen offset:2048 nt
buffer_load_dwordx4 v[140:143], v3, s[12:15], s72 offen offset:3072 nt
s_add_u32 s72, s76, 114688
buffer_load_dwordx4 v[144:147], v3, s[12:15], s72 offen offset:0 nt
buffer_load_dwordx4 v[148:151], v3, s[12:15], s72 offen offset:1024 nt
buffer_load_dwordx4 v[152:155], v3, s[12:15], s72 offen offset:2048 nt
buffer_load_dwordx4 v[156:159], v3, s[12:15], s72 offen offset:3072 nt
s_waitcnt vmcnt(14)
s_branch vb14
vs14:
s_waitcnt vmcnt(6)
vb14:
s_barrier
s_add_u32 s79, s68, 13
s_and_b32 s79, s79, 7
s_or_b32 s79, s79, 8
s_lshl_b32 s72, s79, 19
s_add_u32 s72, s72, s60
s_add_u32 m0, s75, 32768
s_add_u32 s72, s72, 0
buffer_load_dwordx4 v4, s[16:19], s72 offen lds
buffer_load_dwordx4 v5, s[16:19], s72 offen offset:1024 lds
s_add_u32 s79, s68, 13
s_and_b32 s79, s79, 7
s_or_b32 s79, s79, 8
s_lshl_b32 s72, s79, 19
s_add_u32 s72, s72, s60
s_add_u32 m0, s75, 40960
s_add_u32 s72, s72, 256
buffer_load_dwordx4 v4, s[16:19], s72 offen lds
buffer_load_dwordx4 v5, s[16:19], s72 offen offset:1024 lds
s_add_u32 s79, s68, 13
s_and_b32 s79, s79, 7
s_or_b32 s79, s79, 8
s_lshl_b32 s73, s79, 7
s_add_u32 s73, s73, s61
s_add_u32 m0, s75, 90112
s_add_u32 s73, s73, 131072
buffer_load_dwordx4 v8, s[4:7], s73 offen lds
buffer_load_dwordx4 v9, s[4:7], s73 offen offset:1024 lds
s_cmp_lg_u32 s62, 2
s_cbranch_scc1 vs15
s_add_u32 s72, s76, 98304
buffer_load_dwordx4 v[128:131], v3, s[12:15], s72 offen offset:0 nt
buffer_load_dwordx4 v[132:135], v3, s[12:15], s72 offen offset:1024 nt
buffer_load_dwordx4 v[136:139], v3, s[12:15], s72 offen offset:2048 nt
buffer_load_dwordx4 v[140:143], v3, s[12:15], s72 offen offset:3072 nt
s_add_u32 s72, s76, 114688
buffer_load_dwordx4 v[144:147], v3, s[12:15], s72 offen offset:0 nt
buffer_load_dwordx4 v[148:151], v3, s[12:15], s72 offen offset:1024 nt
buffer_load_dwordx4 v[152:155], v3, s[12:15], s72 offen offset:2048 nt
buffer_load_dwordx4 v[156:159], v3, s[12:15], s72 offen offset:3072 nt
s_waitcnt vmcnt(14)
s_branch vb15
vs15:
s_waitcnt vmcnt(6)
vb15:
s_barrier
s_add_u32 s79, s68, 13
s_and_b32 s79, s79, 7
s_or_b32 s79, s79, 8
s_lshl_b32 s72, s79, 19
s_add_u32 s72, s72, s60
s_add_u32 m0, s75, 49152
s_add_u32 s72, s72, 262144
buffer_load_dwordx4 v4, s[16:19], s72 offen lds
buffer_load_dwordx4 v5, s[16:19], s72 offen offset:1024 lds
s_add_u32 s79, s68, 13
s_and_b32 s79, s79, 7
s_or_b32 s79, s79, 8
s_lshl_b32 s72, s79, 19
s_add_u32 s72, s72, s60
s_add_u32 m0, s75, 57344
s_add_u32 s72, s72, 262400
buffer_load_dwordx4 v4, s[16:19], s72 offen lds
buffer_load_dwordx4 v5, s[16:19], s72 offen offset:1024 lds
s_add_u32 s79, s68, 14
s_and_b32 s79, s79, 7
s_or_b32 s79, s79, 8
s_lshl_b32 s73, s79, 7
s_add_u32 s73, s73, s61
s_add_u32 m0, s75, 98304
s_add_u32 s73, s73, 0
buffer_load_dwordx4 v8, s[4:7], s73 offen lds
buffer_load_dwordx4 v9, s[4:7], s73 offen offset:1024 lds
s_cmp_lg_u32 s62, 3
s_cbranch_scc1 vs16
s_add_u32 s72, s76, 98304
buffer_load_dwordx4 v[128:131], v3, s[12:15], s72 offen offset:0 nt
buffer_load_dwordx4 v[132:135], v3, s[12:15], s72 offen offset:1024 nt
buffer_load_dwordx4 v[136:139], v3, s[12:15], s72 offen offset:2048 nt
buffer_load_dwordx4 v[140:143], v3, s[12:15], s72 offen offset:3072 nt
s_add_u32 s72, s76, 114688
buffer_load_dwordx4 v[144:147], v3, s[12:15], s72 offen offset:0 nt
buffer_load_dwordx4 v[148:151], v3, s[12:15], s72 offen offset:1024 nt
buffer_load_dwordx4 v[152:155], v3, s[12:15], s72 offen offset:2048 nt
buffer_load_dwordx4 v[156:159], v3, s[12:15], s72 offen offset:3072 nt
s_waitcnt vmcnt(14)
s_branch vb16
vs16:
s_waitcnt vmcnt(6)
vb16:
s_barrier
s_add_u32 s79, s68, 14
s_and_b32 s79, s79, 7
s_or_b32 s79, s79, 8
s_lshl_b32 s72, s79, 19
s_add_u32 s72, s72, s60
s_add_u32 m0, s75, 0
s_add_u32 s72, s72, 0
buffer_load_dwordx4 v4, s[16:19], s72 offen lds
buffer_load_dwordx4 v5, s[16:19], s72 offen offset:1024 lds
s_add_u32 s79, s68, 14
s_and_b32 s79, s79, 7
s_or_b32 s79, s79, 8
s_lshl_b32 s72, s79, 19
s_add_u32 s72, s72, s60
s_add_u32 m0, s75, 8192
s_add_u32 s72, s72, 256
buffer_load_dwordx4 v4, s[16:19], s72 offen lds
buffer_load_dwordx4 v5, s[16:19], s72 offen offset:1024 lds
s_add_u32 s79, s68, 14
s_and_b32 s79, s79, 7
s_or_b32 s79, s79, 8
s_lshl_b32 s73, s79, 7
s_add_u32 s73, s73, s61
s_add_u32 m0, s75, 106496
s_add_u32 s73, s73, 131072
buffer_load_dwordx4 v8, s[4:7], s73 offen lds
buffer_load_dwordx4 v9, s[4:7], s73 offen offset:1024 lds
s_waitcnt vmcnt(6)
s_barrier
s_add_u32 s79, s68, 14
s_and_b32 s79, s79, 7
s_or_b32 s79, s79, 8
s_lshl_b32 s72, s79, 19
s_add_u32 s72, s72, s60
s_add_u32 m0, s75, 16384
s_add_u32 s72, s72, 262144
buffer_load_dwordx4 v4, s[16:19], s72 offen lds
buffer_load_dwordx4 v5, s[16:19], s72 offen offset:1024 lds
s_add_u32 s79, s68, 14
s_and_b32 s79, s79, 7
s_or_b32 s79, s79, 8
s_lshl_b32 s72, s79, 19
s_add_u32 s72, s72, s60
s_add_u32 m0, s75, 24576
s_add_u32 s72, s72, 262400
buffer_load_dwordx4 v4, s[16:19], s72 offen lds
buffer_load_dwordx4 v5, s[16:19], s72 offen offset:1024 lds
s_add_u32 s79, s68, 15
s_and_b32 s79, s79, 7
s_or_b32 s79, s79, 8
s_lshl_b32 s73, s79, 7
s_add_u32 s73, s73, s61
s_add_u32 m0, s75, 114688
s_add_u32 s73, s73, 0
buffer_load_dwordx4 v8, s[4:7], s73 offen lds
buffer_load_dwordx4 v9, s[4:7], s73 offen offset:1024 lds
s_waitcnt vmcnt(6)
s_barrier
s_add_u32 s79, s68, 15
s_and_b32 s79, s79, 7
s_or_b32 s79, s79, 8
s_lshl_b32 s72, s79, 19
s_add_u32 s72, s72, s60
s_add_u32 m0, s75, 32768
s_add_u32 s72, s72, 0
buffer_load_dwordx4 v4, s[16:19], s72 offen lds
buffer_load_dwordx4 v5, s[16:19], s72 offen offset:1024 lds
s_add_u32 s79, s68, 15
s_and_b32 s79, s79, 7
s_or_b32 s79, s79, 8
s_lshl_b32 s72, s79, 19
s_add_u32 s72, s72, s60
s_add_u32 m0, s75, 40960
s_add_u32 s72, s72, 256
buffer_load_dwordx4 v4, s[16:19], s72 offen lds
buffer_load_dwordx4 v5, s[16:19], s72 offen offset:1024 lds
s_add_u32 s79, s68, 15
s_and_b32 s79, s79, 7
s_or_b32 s79, s79, 8
s_lshl_b32 s73, s79, 7
s_add_u32 s73, s73, s61
s_add_u32 m0, s75, 122880
s_add_u32 s73, s73, 131072
buffer_load_dwordx4 v8, s[4:7], s73 offen lds
buffer_load_dwordx4 v9, s[4:7], s73 offen offset:1024 lds
s_waitcnt vmcnt(6)
s_barrier
s_add_u32 s79, s68, 15
s_and_b32 s79, s79, 7
s_or_b32 s79, s79, 8
s_lshl_b32 s72, s79, 19
s_add_u32 s72, s72, s60
s_add_u32 m0, s75, 49152
s_add_u32 s72, s72, 262144
buffer_load_dwordx4 v4, s[16:19], s72 offen lds
buffer_load_dwordx4 v5, s[16:19], s72 offen offset:1024 lds
s_add_u32 s79, s68, 15
s_and_b32 s79, s79, 7
s_or_b32 s79, s79, 8
s_lshl_b32 s72, s79, 19
s_add_u32 s72, s72, s60
s_add_u32 m0, s75, 57344
s_add_u32 s72, s72, 262400
buffer_load_dwordx4 v4, s[16:19], s72 offen lds
buffer_load_dwordx4 v5, s[16:19], s72 offen offset:1024 lds
s_waitcnt vmcnt(4)
s_barrier
s_add_u32 m0, s75, 131072
s_add_u32 s72, s76, 0
buffer_load_dwordx4 v1, s[8:11], s72 offen nt lds
s_waitcnt vmcnt(4)
buffer_load_dwordx4 v2, s[8:11], s72 offen offset:1024 nt lds
s_waitcnt vmcnt(4)
s_add_u32 m0, s75, 0
s_add_u32 s72, s76, 8192
buffer_load_dwordx4 v1, s[8:11], s72 offen nt lds
s_waitcnt vmcnt(4)
buffer_load_dwordx4 v2, s[8:11], s72 offen offset:1024 nt lds
s_waitcnt vmcnt(4)
s_add_u32 m0, s75, 8192
s_add_u32 s72, s76, 16384
buffer_load_dwordx4 v1, s[8:11], s72 offen nt lds
s_waitcnt vmcnt(4)
buffer_load_dwordx4 v2, s[8:11], s72 offen offset:1024 nt lds
s_waitcnt vmcnt(4)
ds_write_b128 v18, v[32:35] offset:0
ds_write_b128 v18, v[36:39] offset:1024
ds_write_b128 v18, v[40:43] offset:2048
ds_write_b128 v18, v[44:47] offset:3072
s_waitcnt vmcnt(6) lgkmcnt(0)
s_barrier
s_add_u32 m0, s75, 16384
s_add_u32 s72, s76, 24576
buffer_load_dwordx4 v1, s[8:11], s72 offen nt lds
s_waitcnt vmcnt(4)
buffer_load_dwordx4 v2, s[8:11], s72 offen offset:1024 nt lds
s_waitcnt vmcnt(4)
s_add_u32 m0, s75, 24576
s_add_u32 s72, s76, 32768
buffer_load_dwordx4 v1, s[8:11], s72 offen nt lds
s_waitcnt vmcnt(4)
buffer_load_dwordx4 v2, s[8:11], s72 offen offset:1024 nt lds
s_waitcnt vmcnt(4)
ds_write_b128 v18, v[48:51] offset:16384
ds_write_b128 v18, v[52:55] offset:17408
ds_write_b128 v18, v[56:59] offset:18432
ds_write_b128 v18, v[60:63] offset:19456
s_waitcnt vmcnt(4) lgkmcnt(0)
s_barrier
s_add_u32 m0, s75, 32768
s_add_u32 s72, s76, 40960
buffer_load_dwordx4 v1, s[8:11], s72 offen nt lds
s_waitcnt vmcnt(4)
buffer_load_dwordx4 v2, s[8:11], s72 offen offset:1024 nt lds
s_waitcnt vmcnt(4)
s_add_u32 m0, s75, 40960
s_add_u32 s72, s76, 49152
buffer_load_dwordx4 v1, s[8:11], s72 offen nt lds
s_waitcnt vmcnt(4)
buffer_load_dwordx4 v2, s[8:11], s72 offen offset:1024 nt lds
s_waitcnt vmcnt(4)
ds_write_b128 v18, v[64:67] offset:32768
ds_write_b128 v18, v[68:71] offset:33792
ds_write_b128 v18, v[72:75] offset:34816
ds_write_b128 v18, v[76:79] offset:35840
s_waitcnt vmcnt(4) lgkmcnt(0)
s_barrier
s_add_u32 m0, s75, 49152
s_add_u32 s72, s76, 57344
buffer_load_dwordx4 v1, s[8:11], s72 offen nt lds
s_waitcnt vmcnt(4)
buffer_load_dwordx4 v2, s[8:11], s72 offen offset:1024 nt lds
s_waitcnt vmcnt(4)
s_add_u32 m0, s75, 57344
s_add_u32 s72, s76, 65536
buffer_load_dwordx4 v1, s[8:11], s72 offen nt lds
s_waitcnt vmcnt(4)
buffer_load_dwordx4 v2, s[8:11], s72 offen offset:1024 nt lds
s_waitcnt vmcnt(4)
ds_write_b128 v18, v[80:83] offset:49152
ds_write_b128 v18, v[84:87] offset:50176
ds_write_b128 v18, v[88:91] offset:51200
ds_write_b128 v18, v[92:95] offset:52224
s_waitcnt vmcnt(4) lgkmcnt(0)
s_barrier
s_add_u32 m0, s75, 0
s_add_u32 s72, s76, 73728
buffer_load_dwordx4 v1, s[8:11], s72 offen nt lds
s_waitcnt vmcnt(3)
buffer_load_dwordx4 v2, s[8:11], s72 offen offset:1024 nt lds
s_waitcnt vmcnt(3)
s_add_u32 m0, s75, 8192
s_add_u32 s72, s76, 81920
buffer_load_dwordx4 v1, s[8:11], s72 offen nt lds
s_waitcnt vmcnt(3)
buffer_load_dwordx4 v2, s[8:11], s72 offen offset:1024 nt lds
s_waitcnt vmcnt(3)
ds_write_b128 v18, v[96:99] offset:0
ds_write_b128 v18, v[100:103] offset:1024
ds_write_b128 v18, v[104:107] offset:2048
ds_write_b128 v18, v[108:111] offset:3072
s_waitcnt vmcnt(4) lgkmcnt(0)
s_barrier
s_add_u32 m0, s75, 16384
s_add_u32 s72, s76, 90112
buffer_load_dwordx4 v1, s[8:11], s72 offen nt lds
s_waitcnt vmcnt(3)
buffer_load_dwordx4 v2, s[8:11], s72 offen offset:1024 nt lds
s_waitcnt vmcnt(3)
s_add_u32 m0, s75, 24576
s_add_u32 s72, s76, 98304
buffer_load_dwordx4 v1, s[8:11], s72 offen nt lds
s_waitcnt vmcnt(3)
buffer_load_dwordx4 v2, s[8:11], s72 offen offset:1024 nt lds
s_waitcnt vmcnt(3)
ds_write_b128 v18, v[112:115] offset:16384
ds_write_b128 v18, v[116:119] offset:17408
ds_write_b128 v18, v[120:123] offset:18432
ds_write_b128 v18, v[124:127] offset:19456
s_waitcnt vmcnt(4) lgkmcnt(0)
s_barrier
s_add_u32 m0, s75, 32768
s_add_u32 s72, s76, 106496
buffer_load_dwordx4 v1, s[8:11], s72 offen nt lds
s_waitcnt vmcnt(3)
buffer_load_dwordx4 v2, s[8:11], s72 offen offset:1024 nt lds
s_waitcnt vmcnt(3)
s_add_u32 m0, s75, 40960
s_add_u32 s72, s76, 114688
buffer_load_dwordx4 v1, s[8:11], s72 offen nt lds
s_waitcnt vmcnt(3)
buffer_load_dwordx4 v2, s[8:11], s72 offen offset:1024 nt lds
s_waitcnt vmcnt(3)
ds_write_b128 v18, v[128:131] offset:32768
ds_write_b128 v18, v[132:135] offset:33792
ds_write_b128 v18, v[136:139] offset:34816
ds_write_b128 v18, v[140:143] offset:35840
s_waitcnt vmcnt(4) lgkmcnt(0)
s_barrier
s_add_u32 m0, s75, 49152
s_add_u32 s72, s76, 122880
buffer_load_dwordx4 v1, s[8:11], s72 offen nt lds
s_waitcnt vmcnt(3)
buffer_load_dwordx4 v2, s[8:11], s72 offen offset:1024 nt lds
s_waitcnt vmcnt(3)
s_add_u32 m0, s75, 57344
s_add_u32 s72, s76, 131072
buffer_load_dwordx4 v1, s[8:11], s72 offen nt lds
s_waitcnt vmcnt(3)
buffer_load_dwordx4 v2, s[8:11], s72 offen offset:1024 nt lds
s_waitcnt vmcnt(3)
ds_write_b128 v18, v[144:147] offset:49152
ds_write_b128 v18, v[148:151] offset:50176
ds_write_b128 v18, v[152:155] offset:51200
ds_write_b128 v18, v[156:159] offset:52224
s_waitcnt vmcnt(4) lgkmcnt(0)
s_barrier
s_add_u32 m0, s75, 0
s_add_u32 s72, s76, 139264
buffer_load_dwordx4 v1, s[8:11], s72 offen nt lds
s_waitcnt vmcnt(4)
buffer_load_dwordx4 v2, s[8:11], s72 offen offset:1024 nt lds
s_waitcnt vmcnt(4)
s_add_u32 m0, s75, 8192
s_add_u32 s72, s76, 147456
buffer_load_dwordx4 v1, s[8:11], s72 offen nt lds
s_waitcnt vmcnt(4)
buffer_load_dwordx4 v2, s[8:11], s72 offen offset:1024 nt lds
s_waitcnt vmcnt(4)
s_add_u32 m0, s74, 65536
s_add_u32 s72, s76, 131072
buffer_load_dwordx4 v3, s[12:15], s72 offen nt lds
s_waitcnt vmcnt(4)
buffer_load_dwordx4 v3, s[12:15], s72 offen offset:1024 nt lds
s_waitcnt vmcnt(4)
buffer_load_dwordx4 v3, s[12:15], s72 offen offset:2048 nt lds
s_waitcnt vmcnt(4)
buffer_load_dwordx4 v3, s[12:15], s72 offen offset:3072 nt lds
s_waitcnt vmcnt(4)
s_waitcnt vmcnt(8)
s_barrier
s_add_u32 m0, s75, 16384
s_add_u32 s72, s76, 155648
buffer_load_dwordx4 v1, s[8:11], s72 offen nt lds
s_waitcnt vmcnt(4)
buffer_load_dwordx4 v2, s[8:11], s72 offen offset:1024 nt lds
s_waitcnt vmcnt(4)
s_add_u32 m0, s75, 24576
s_add_u32 s72, s76, 163840
buffer_load_dwordx4 v1, s[8:11], s72 offen nt lds
s_waitcnt vmcnt(4)
buffer_load_dwordx4 v2, s[8:11], s72 offen offset:1024 nt lds
s_waitcnt vmcnt(4)
s_add_u32 m0, s74, 81920
s_add_u32 s72, s76, 147456
buffer_load_dwordx4 v3, s[12:15], s72 offen nt lds
s_waitcnt vmcnt(4)
buffer_load_dwordx4 v3, s[12:15], s72 offen offset:1024 nt lds
s_waitcnt vmcnt(4)
buffer_load_dwordx4 v3, s[12:15], s72 offen offset:2048 nt lds
s_waitcnt vmcnt(4)
buffer_load_dwordx4 v3, s[12:15], s72 offen offset:3072 nt lds
s_waitcnt vmcnt(4)
s_waitcnt vmcnt(8)
s_barrier
s_add_u32 m0, s75, 32768
s_add_u32 s72, s76, 172032
buffer_load_dwordx4 v1, s[8:11], s72 offen nt lds
s_waitcnt vmcnt(4)
buffer_load_dwordx4 v2, s[8:11], s72 offen offset:1024 nt lds
s_waitcnt vmcnt(4)
s_add_u32 m0, s75, 40960
s_add_u32 s72, s76, 180224
buffer_load_dwordx4 v1, s[8:11], s72 offen nt lds
s_waitcnt vmcnt(4)
buffer_load_dwordx4 v2, s[8:11], s72 offen offset:1024 nt lds
s_waitcnt vmcnt(4)
s_add_u32 m0, s74, 98304
s_add_u32 s72, s76, 163840
buffer_load_dwordx4 v3, s[12:15], s72 offen nt lds
s_waitcnt vmcnt(4)
buffer_load_dwordx4 v3, s[12:15], s72 offen offset:1024 nt lds
s_waitcnt vmcnt(4)
buffer_load_dwordx4 v3, s[12:15], s72 offen offset:2048 nt lds
s_waitcnt vmcnt(4)
buffer_load_dwordx4 v3, s[12:15], s72 offen offset:3072 nt lds
s_waitcnt vmcnt(4)
s_waitcnt vmcnt(8)
s_barrier
s_add_u32 m0, s75, 49152
s_add_u32 s72, s76, 188416
buffer_load_dwordx4 v1, s[8:11], s72 offen nt lds
s_waitcnt vmcnt(4)
buffer_load_dwordx4 v2, s[8:11], s72 offen offset:1024 nt lds
s_waitcnt vmcnt(4)
s_add_u32 m0, s75, 57344
s_add_u32 s72, s76, 196608
buffer_load_dwordx4 v1, s[8:11], s72 offen nt lds
s_waitcnt vmcnt(4)
buffer_load_dwordx4 v2, s[8:11], s72 offen offset:1024 nt lds
s_waitcnt vmcnt(4)
s_add_u32 m0, s74, 114688
s_add_u32 s72, s76, 180224
buffer_load_dwordx4 v3, s[12:15], s72 offen nt lds
s_waitcnt vmcnt(4)
buffer_load_dwordx4 v3, s[12:15], s72 offen offset:1024 nt lds
s_waitcnt vmcnt(4)
buffer_load_dwordx4 v3, s[12:15], s72 offen offset:2048 nt lds
s_waitcnt vmcnt(4)
buffer_load_dwordx4 v3, s[12:15], s72 offen offset:3072 nt lds
s_waitcnt vmcnt(4)
s_waitcnt vmcnt(8)
s_barrier
s_add_u32 m0, s75, 0
s_add_u32 s72, s76, 204800
buffer_load_dwordx4 v1, s[8:11], s72 offen nt lds
s_waitcnt vmcnt(4)
buffer_load_dwordx4 v2, s[8:11], s72 offen offset:1024 nt lds
s_waitcnt vmcnt(4)
s_add_u32 m0, s75, 8192
s_add_u32 s72, s76, 212992
buffer_load_dwordx4 v1, s[8:11], s72 offen nt lds
s_waitcnt vmcnt(4)
buffer_load_dwordx4 v2, s[8:11], s72 offen offset:1024 nt lds
s_waitcnt vmcnt(4)
s_add_u32 m0, s74, 65536
s_add_u32 s72, s76, 196608
buffer_load_dwordx4 v3, s[12:15], s72 offen nt lds
s_waitcnt vmcnt(4)
buffer_load_dwordx4 v3, s[12:15], s72 offen offset:1024 nt lds
s_waitcnt vmcnt(4)
buffer_load_dwordx4 v3, s[12:15], s72 offen offset:2048 nt lds
s_waitcnt vmcnt(4)
buffer_load_dwordx4 v3, s[12:15], s72 offen offset:3072 nt lds
s_waitcnt vmcnt(4)
s_waitcnt vmcnt(8)
s_barrier
s_add_u32 m0, s75, 16384
s_add_u32 s72, s76, 221184
buffer_load_dwordx4 v1, s[8:11], s72 offen nt lds
s_waitcnt vmcnt(4)
buffer_load_dwordx4 v2, s[8:11], s72 offen offset:1024 nt lds
s_waitcnt vmcnt(4)
s_add_u32 m0, s75, 24576
s_add_u32 s72, s76, 229376
buffer_load_dwordx4 v1, s[8:11], s72 offen nt lds
s_waitcnt vmcnt(4)
buffer_load_dwordx4 v2, s[8:11], s72 offen offset:1024 nt lds
s_waitcnt vmcnt(4)
s_add_u32 m0, s74, 81920
s_add_u32 s72, s76, 212992
buffer_load_dwordx4 v3, s[12:15], s72 offen nt lds
s_waitcnt vmcnt(4)
buffer_load_dwordx4 v3, s[12:15], s72 offen offset:1024 nt lds
s_waitcnt vmcnt(4)
buffer_load_dwordx4 v3, s[12:15], s72 offen offset:2048 nt lds
s_waitcnt vmcnt(4)
buffer_load_dwordx4 v3, s[12:15], s72 offen offset:3072 nt lds
s_waitcnt vmcnt(4)
s_waitcnt vmcnt(8)
s_barrier
s_add_u32 m0, s75, 32768
s_add_u32 s72, s76, 237568
buffer_load_dwordx4 v1, s[8:11], s72 offen nt lds
s_waitcnt vmcnt(4)
buffer_load_dwordx4 v2, s[8:11], s72 offen offset:1024 nt lds
s_waitcnt vmcnt(4)
s_add_u32 m0, s75, 40960
s_add_u32 s72, s76, 245760
buffer_load_dwordx4 v1, s[8:11], s72 offen nt lds
s_waitcnt vmcnt(4)
buffer_load_dwordx4 v2, s[8:11], s72 offen offset:1024 nt lds
s_waitcnt vmcnt(4)
s_add_u32 m0, s74, 98304
s_add_u32 s72, s76, 229376
buffer_load_dwordx4 v3, s[12:15], s72 offen nt lds
s_waitcnt vmcnt(4)
buffer_load_dwordx4 v3, s[12:15], s72 offen offset:1024 nt lds
s_waitcnt vmcnt(4)
buffer_load_dwordx4 v3, s[12:15], s72 offen offset:2048 nt lds
s_waitcnt vmcnt(4)
buffer_load_dwordx4 v3, s[12:15], s72 offen offset:3072 nt lds
s_waitcnt vmcnt(4)
s_waitcnt vmcnt(8)
s_barrier
s_add_u32 m0, s75, 49152
s_add_u32 s72, s76, 253952
buffer_load_dwordx4 v1, s[8:11], s72 offen nt lds
s_waitcnt vmcnt(4)
buffer_load_dwordx4 v2, s[8:11], s72 offen offset:1024 nt lds
s_waitcnt vmcnt(4)
s_add_u32 m0, s74, 114688
s_add_u32 s72, s76, 245760
buffer_load_dwordx4 v3, s[12:15], s72 offen nt lds
s_waitcnt vmcnt(4)
buffer_load_dwordx4 v3, s[12:15], s72 offen offset:1024 nt lds
s_waitcnt vmcnt(4)
buffer_load_dwordx4 v3, s[12:15], s72 offen offset:2048 nt lds
s_waitcnt vmcnt(4)
buffer_load_dwordx4 v3, s[12:15], s72 offen offset:3072 nt lds
s_waitcnt vmcnt(4)
s_waitcnt vmcnt(6)
s_barrier
s_add_u32 m0, s75, 131072
s_add_u32 s72, s76, 262144
buffer_load_dwordx4 v1, s[8:11], s72 offen nt lds
s_waitcnt vmcnt(4)
buffer_load_dwordx4 v2, s[8:11], s72 offen offset:1024 nt lds
s_waitcnt vmcnt(4)
s_add_u32 m0, s75, 0
s_add_u32 s72, s76, 270336
buffer_load_dwordx4 v1, s[8:11], s72 offen nt lds
s_waitcnt vmcnt(4)
buffer_load_dwordx4 v2, s[8:11], s72 offen offset:1024 nt lds
s_waitcnt vmcnt(4)
s_add_u32 m0, s75, 8192
s_add_u32 s72, s76, 278528
buffer_load_dwordx4 v1, s[8:11], s72 offen nt lds
s_waitcnt vmcnt(4)
buffer_load_dwordx4 v2, s[8:11], s72 offen offset:1024 nt lds
s_waitcnt vmcnt(4)
s_add_u32 m0, s74, 65536
s_add_u32 s72, s76, 262144
buffer_load_dwordx4 v3, s[12:15], s72 offen nt lds
s_waitcnt vmcnt(4)
buffer_load_dwordx4 v3, s[12:15], s72 offen offset:1024 nt lds
s_waitcnt vmcnt(4)
buffer_load_dwordx4 v3, s[12:15], s72 offen offset:2048 nt lds
s_waitcnt vmcnt(4)
buffer_load_dwordx4 v3, s[12:15], s72 offen offset:3072 nt lds
s_waitcnt vmcnt(4)
s_waitcnt vmcnt(10)
s_barrier
s_add_u32 m0, s75, 16384
s_add_u32 s72, s76, 286720
buffer_load_dwordx4 v1, s[8:11], s72 offen nt lds
s_waitcnt vmcnt(4)
buffer_load_dwordx4 v2, s[8:11], s72 offen offset:1024 nt lds
s_waitcnt vmcnt(4)
s_add_u32 m0, s75, 24576
s_add_u32 s72, s76, 294912
buffer_load_dwordx4 v1, s[8:11], s72 offen nt lds
s_waitcnt vmcnt(4)
buffer_load_dwordx4 v2, s[8:11], s72 offen offset:1024 nt lds
s_waitcnt vmcnt(4)
s_add_u32 m0, s74, 81920
s_add_u32 s72, s76, 278528
buffer_load_dwordx4 v3, s[12:15], s72 offen nt lds
s_waitcnt vmcnt(4)
buffer_load_dwordx4 v3, s[12:15], s72 offen offset:1024 nt lds
s_waitcnt vmcnt(4)
buffer_load_dwordx4 v3, s[12:15], s72 offen offset:2048 nt lds
s_waitcnt vmcnt(4)
buffer_load_dwordx4 v3, s[12:15], s72 offen offset:3072 nt lds
s_waitcnt vmcnt(4)
s_waitcnt vmcnt(8)
s_barrier
s_add_u32 m0, s75, 32768
s_add_u32 s72, s76, 303104
buffer_load_dwordx4 v1, s[8:11], s72 offen nt lds
s_waitcnt vmcnt(4)
buffer_load_dwordx4 v2, s[8:11], s72 offen offset:1024 nt lds
s_waitcnt vmcnt(4)
s_add_u32 m0, s75, 40960
s_add_u32 s72, s76, 311296
buffer_load_dwordx4 v1, s[8:11], s72 offen nt lds
s_waitcnt vmcnt(4)
buffer_load_dwordx4 v2, s[8:11], s72 offen offset:1024 nt lds
s_waitcnt vmcnt(4)
s_add_u32 m0, s74, 98304
s_add_u32 s72, s76, 294912
buffer_load_dwordx4 v3, s[12:15], s72 offen nt lds
s_waitcnt vmcnt(4)
buffer_load_dwordx4 v3, s[12:15], s72 offen offset:1024 nt lds
s_waitcnt vmcnt(4)
buffer_load_dwordx4 v3, s[12:15], s72 offen offset:2048 nt lds
s_waitcnt vmcnt(4)
buffer_load_dwordx4 v3, s[12:15], s72 offen offset:3072 nt lds
s_waitcnt vmcnt(4)
s_waitcnt vmcnt(8)
s_barrier
s_add_u32 m0, s75, 49152
s_add_u32 s72, s76, 319488
buffer_load_dwordx4 v1, s[8:11], s72 offen nt lds
s_waitcnt vmcnt(4)
buffer_load_dwordx4 v2, s[8:11], s72 offen offset:1024 nt lds
s_waitcnt vmcnt(4)
s_add_u32 m0, s75, 57344
s_add_u32 s72, s76, 327680
buffer_load_dwordx4 v1, s[8:11], s72 offen nt lds
s_waitcnt vmcnt(4)
buffer_load_dwordx4 v2, s[8:11], s72 offen offset:1024 nt lds
s_waitcnt vmcnt(4)
s_add_u32 m0, s74, 114688
s_add_u32 s72, s76, 311296
buffer_load_dwordx4 v3, s[12:15], s72 offen nt lds
s_waitcnt vmcnt(4)
buffer_load_dwordx4 v3, s[12:15], s72 offen offset:1024 nt lds
s_waitcnt vmcnt(4)
buffer_load_dwordx4 v3, s[12:15], s72 offen offset:2048 nt lds
s_waitcnt vmcnt(4)
buffer_load_dwordx4 v3, s[12:15], s72 offen offset:3072 nt lds
s_waitcnt vmcnt(4)
s_waitcnt vmcnt(8)
s_barrier
s_add_u32 m0, s75, 0
s_add_u32 s72, s76, 335872
buffer_load_dwordx4 v1, s[8:11], s72 offen nt lds
s_waitcnt vmcnt(4)
buffer_load_dwordx4 v2, s[8:11], s72 offen offset:1024 nt lds
s_waitcnt vmcnt(4)
s_add_u32 m0, s75, 8192
s_add_u32 s72, s76, 344064
buffer_load_dwordx4 v1, s[8:11], s72 offen nt lds
s_waitcnt vmcnt(4)
buffer_load_dwordx4 v2, s[8:11], s72 offen offset:1024 nt lds
s_waitcnt vmcnt(4)
s_add_u32 m0, s74, 65536
s_add_u32 s72, s76, 327680
buffer_load_dwordx4 v3, s[12:15], s72 offen nt lds
s_waitcnt vmcnt(4)
buffer_load_dwordx4 v3, s[12:15], s72 offen offset:1024 nt lds
s_waitcnt vmcnt(4)
buffer_load_dwordx4 v3, s[12:15], s72 offen offset:2048 nt lds
s_waitcnt vmcnt(4)
buffer_load_dwordx4 v3, s[12:15], s72 offen offset:3072 nt lds
s_waitcnt vmcnt(4)
s_waitcnt vmcnt(8)
s_barrier
s_add_u32 m0, s75, 16384
s_add_u32 s72, s76, 352256
buffer_load_dwordx4 v1, s[8:11], s72 offen nt lds
s_waitcnt vmcnt(4)
buffer_load_dwordx4 v2, s[8:11], s72 offen offset:1024 nt lds
s_waitcnt vmcnt(4)
s_add_u32 m0, s75, 24576
s_add_u32 s72, s76, 360448
buffer_load_dwordx4 v1, s[8:11], s72 offen nt lds
s_waitcnt vmcnt(4)
buffer_load_dwordx4 v2, s[8:11], s72 offen offset:1024 nt lds
s_waitcnt vmcnt(4)
s_add_u32 m0, s74, 81920
s_add_u32 s72, s76, 344064
buffer_load_dwordx4 v3, s[12:15], s72 offen nt lds
s_waitcnt vmcnt(4)
buffer_load_dwordx4 v3, s[12:15], s72 offen offset:1024 nt lds
s_waitcnt vmcnt(4)
buffer_load_dwordx4 v3, s[12:15], s72 offen offset:2048 nt lds
s_waitcnt vmcnt(4)
buffer_load_dwordx4 v3, s[12:15], s72 offen offset:3072 nt lds
s_waitcnt vmcnt(4)
s_waitcnt vmcnt(8)
s_barrier
s_add_u32 m0, s75, 32768
s_add_u32 s72, s76, 368640
buffer_load_dwordx4 v1, s[8:11], s72 offen nt lds
s_waitcnt vmcnt(4)
buffer_load_dwordx4 v2, s[8:11], s72 offen offset:1024 nt lds
s_waitcnt vmcnt(4)
s_add_u32 m0, s75, 40960
s_add_u32 s72, s76, 376832
buffer_load_dwordx4 v1, s[8:11], s72 offen nt lds
s_waitcnt vmcnt(4)
buffer_load_dwordx4 v2, s[8:11], s72 offen offset:1024 nt lds
s_waitcnt vmcnt(4)
s_add_u32 m0, s74, 98304
s_add_u32 s72, s76, 360448
buffer_load_dwordx4 v3, s[12:15], s72 offen nt lds
s_waitcnt vmcnt(4)
buffer_load_dwordx4 v3, s[12:15], s72 offen offset:1024 nt lds
s_waitcnt vmcnt(4)
buffer_load_dwordx4 v3, s[12:15], s72 offen offset:2048 nt lds
s_waitcnt vmcnt(4)
buffer_load_dwordx4 v3, s[12:15], s72 offen offset:3072 nt lds
s_waitcnt vmcnt(4)
s_waitcnt vmcnt(8)
s_barrier
s_add_u32 m0, s75, 49152
s_add_u32 s72, s76, 385024
buffer_load_dwordx4 v1, s[8:11], s72 offen nt lds
s_waitcnt vmcnt(4)
buffer_load_dwordx4 v2, s[8:11], s72 offen offset:1024 nt lds
s_waitcnt vmcnt(4)
s_add_u32 m0, s75, 57344
s_add_u32 s72, s76, 393216
buffer_load_dwordx4 v1, s[8:11], s72 offen nt lds
s_waitcnt vmcnt(4)
buffer_load_dwordx4 v2, s[8:11], s72 offen offset:1024 nt lds
s_waitcnt vmcnt(4)
s_add_u32 m0, s74, 114688
s_add_u32 s72, s76, 376832
buffer_load_dwordx4 v3, s[12:15], s72 offen nt lds
s_waitcnt vmcnt(4)
buffer_load_dwordx4 v3, s[12:15], s72 offen offset:1024 nt lds
s_waitcnt vmcnt(4)
buffer_load_dwordx4 v3, s[12:15], s72 offen offset:2048 nt lds
s_waitcnt vmcnt(4)
buffer_load_dwordx4 v3, s[12:15], s72 offen offset:3072 nt lds
s_waitcnt vmcnt(4)
s_waitcnt vmcnt(8)
s_barrier
s_add_u32 m0, s75, 0
s_add_u32 s72, s76, 401408
buffer_load_dwordx4 v1, s[8:11], s72 offen nt lds
s_waitcnt vmcnt(4)
buffer_load_dwordx4 v2, s[8:11], s72 offen offset:1024 nt lds
s_waitcnt vmcnt(4)
s_add_u32 m0, s75, 8192
s_add_u32 s72, s76, 409600
buffer_load_dwordx4 v1, s[8:11], s72 offen nt lds
s_waitcnt vmcnt(4)
buffer_load_dwordx4 v2, s[8:11], s72 offen offset:1024 nt lds
s_waitcnt vmcnt(4)
s_add_u32 m0, s74, 65536
s_add_u32 s72, s76, 393216
buffer_load_dwordx4 v3, s[12:15], s72 offen nt lds
s_waitcnt vmcnt(4)
buffer_load_dwordx4 v3, s[12:15], s72 offen offset:1024 nt lds
s_waitcnt vmcnt(4)
buffer_load_dwordx4 v3, s[12:15], s72 offen offset:2048 nt lds
s_waitcnt vmcnt(4)
buffer_load_dwordx4 v3, s[12:15], s72 offen offset:3072 nt lds
s_waitcnt vmcnt(4)
s_waitcnt vmcnt(8)
s_barrier
s_add_u32 m0, s75, 16384
s_add_u32 s72, s76, 417792
buffer_load_dwordx4 v1, s[8:11], s72 offen nt lds
s_waitcnt vmcnt(4)
buffer_load_dwordx4 v2, s[8:11], s72 offen offset:1024 nt lds
s_waitcnt vmcnt(4)
s_add_u32 m0, s75, 24576
s_add_u32 s72, s76, 425984
buffer_load_dwordx4 v1, s[8:11], s72 offen nt lds
s_waitcnt vmcnt(4)
buffer_load_dwordx4 v2, s[8:11], s72 offen offset:1024 nt lds
s_waitcnt vmcnt(4)
s_add_u32 m0, s74, 81920
s_add_u32 s72, s76, 409600
buffer_load_dwordx4 v3, s[12:15], s72 offen nt lds
s_waitcnt vmcnt(4)
buffer_load_dwordx4 v3, s[12:15], s72 offen offset:1024 nt lds
s_waitcnt vmcnt(4)
buffer_load_dwordx4 v3, s[12:15], s72 offen offset:2048 nt lds
s_waitcnt vmcnt(4)
buffer_load_dwordx4 v3, s[12:15], s72 offen offset:3072 nt lds
s_waitcnt vmcnt(4)
s_waitcnt vmcnt(8)
s_barrier
s_add_u32 m0, s75, 32768
s_add_u32 s72, s76, 434176
buffer_load_dwordx4 v1, s[8:11], s72 offen nt lds
s_waitcnt vmcnt(4)
buffer_load_dwordx4 v2, s[8:11], s72 offen offset:1024 nt lds
s_waitcnt vmcnt(4)
s_add_u32 m0, s75, 40960
s_add_u32 s72, s76, 442368
buffer_load_dwordx4 v1, s[8:11], s72 offen nt lds
s_waitcnt vmcnt(4)
buffer_load_dwordx4 v2, s[8:11], s72 offen offset:1024 nt lds
s_waitcnt vmcnt(4)
s_add_u32 m0, s74, 98304
s_add_u32 s72, s76, 425984
buffer_load_dwordx4 v3, s[12:15], s72 offen nt lds
s_waitcnt vmcnt(4)
buffer_load_dwordx4 v3, s[12:15], s72 offen offset:1024 nt lds
s_waitcnt vmcnt(4)
buffer_load_dwordx4 v3, s[12:15], s72 offen offset:2048 nt lds
s_waitcnt vmcnt(4)
buffer_load_dwordx4 v3, s[12:15], s72 offen offset:3072 nt lds
s_waitcnt vmcnt(4)
s_waitcnt vmcnt(8)
s_barrier
s_add_u32 m0, s75, 49152
s_add_u32 s72, s76, 450560
buffer_load_dwordx4 v1, s[8:11], s72 offen nt lds
s_waitcnt vmcnt(4)
buffer_load_dwordx4 v2, s[8:11], s72 offen offset:1024 nt lds
s_waitcnt vmcnt(4)
s_add_u32 m0, s75, 57344
s_add_u32 s72, s76, 458752
buffer_load_dwordx4 v1, s[8:11], s72 offen nt lds
s_waitcnt vmcnt(4)
buffer_load_dwordx4 v2, s[8:11], s72 offen offset:1024 nt lds
s_waitcnt vmcnt(4)
s_add_u32 m0, s74, 114688
s_add_u32 s72, s76, 442368
buffer_load_dwordx4 v3, s[12:15], s72 offen nt lds
s_waitcnt vmcnt(4)
buffer_load_dwordx4 v3, s[12:15], s72 offen offset:1024 nt lds
s_waitcnt vmcnt(4)
buffer_load_dwordx4 v3, s[12:15], s72 offen offset:2048 nt lds
s_waitcnt vmcnt(4)
buffer_load_dwordx4 v3, s[12:15], s72 offen offset:3072 nt lds
s_waitcnt vmcnt(4)
s_waitcnt vmcnt(8)
s_barrier
s_add_u32 m0, s75, 0
s_add_u32 s72, s76, 466944
buffer_load_dwordx4 v1, s[8:11], s72 offen nt lds
s_waitcnt vmcnt(4)
buffer_load_dwordx4 v2, s[8:11], s72 offen offset:1024 nt lds
s_waitcnt vmcnt(4)
s_add_u32 m0, s75, 8192
s_add_u32 s72, s76, 475136
buffer_load_dwordx4 v1, s[8:11], s72 offen nt lds
s_waitcnt vmcnt(4)
buffer_load_dwordx4 v2, s[8:11], s72 offen offset:1024 nt lds
s_waitcnt vmcnt(4)
s_add_u32 m0, s74, 65536
s_add_u32 s72, s76, 458752
buffer_load_dwordx4 v3, s[12:15], s72 offen nt lds
s_waitcnt vmcnt(4)
buffer_load_dwordx4 v3, s[12:15], s72 offen offset:1024 nt lds
s_waitcnt vmcnt(4)
buffer_load_dwordx4 v3, s[12:15], s72 offen offset:2048 nt lds
s_waitcnt vmcnt(4)
buffer_load_dwordx4 v3, s[12:15], s72 offen offset:3072 nt lds
s_waitcnt vmcnt(4)
s_waitcnt vmcnt(8)
s_barrier
s_add_u32 m0, s75, 16384
s_add_u32 s72, s76, 483328
buffer_load_dwordx4 v1, s[8:11], s72 offen nt lds
s_waitcnt vmcnt(4)
buffer_load_dwordx4 v2, s[8:11], s72 offen offset:1024 nt lds
s_waitcnt vmcnt(4)
s_add_u32 m0, s75, 24576
s_add_u32 s72, s76, 491520
buffer_load_dwordx4 v1, s[8:11], s72 offen nt lds
s_waitcnt vmcnt(4)
buffer_load_dwordx4 v2, s[8:11], s72 offen offset:1024 nt lds
s_waitcnt vmcnt(4)
s_add_u32 m0, s74, 81920
s_add_u32 s72, s76, 475136
buffer_load_dwordx4 v3, s[12:15], s72 offen nt lds
s_waitcnt vmcnt(4)
buffer_load_dwordx4 v3, s[12:15], s72 offen offset:1024 nt lds
s_waitcnt vmcnt(4)
buffer_load_dwordx4 v3, s[12:15], s72 offen offset:2048 nt lds
s_waitcnt vmcnt(4)
buffer_load_dwordx4 v3, s[12:15], s72 offen offset:3072 nt lds
s_waitcnt vmcnt(4)
s_waitcnt vmcnt(8)
s_barrier
s_add_u32 m0, s75, 32768
s_add_u32 s72, s76, 499712
buffer_load_dwordx4 v1, s[8:11], s72 offen nt lds
s_waitcnt vmcnt(4)
buffer_load_dwordx4 v2, s[8:11], s72 offen offset:1024 nt lds
s_waitcnt vmcnt(4)
s_add_u32 m0, s75, 40960
s_add_u32 s72, s76, 507904
buffer_load_dwordx4 v1, s[8:11], s72 offen nt lds
s_waitcnt vmcnt(4)
buffer_load_dwordx4 v2, s[8:11], s72 offen offset:1024 nt lds
s_waitcnt vmcnt(4)
s_add_u32 m0, s74, 98304
s_add_u32 s72, s76, 491520
buffer_load_dwordx4 v3, s[12:15], s72 offen nt lds
s_waitcnt vmcnt(4)
buffer_load_dwordx4 v3, s[12:15], s72 offen offset:1024 nt lds
s_waitcnt vmcnt(4)
buffer_load_dwordx4 v3, s[12:15], s72 offen offset:2048 nt lds
s_waitcnt vmcnt(4)
buffer_load_dwordx4 v3, s[12:15], s72 offen offset:3072 nt lds
s_waitcnt vmcnt(4)
global_load_dwordx4 v[20:23], v17, s[56:57] sc1
s_waitcnt vmcnt(9)
s_barrier
s_add_u32 m0, s75, 49152
s_add_u32 s72, s76, 516096
buffer_load_dwordx4 v1, s[8:11], s72 offen nt lds
s_waitcnt vmcnt(4)
buffer_load_dwordx4 v2, s[8:11], s72 offen offset:1024 nt lds
s_waitcnt vmcnt(4)
s_add_u32 m0, s74, 114688
s_add_u32 s72, s76, 507904
buffer_load_dwordx4 v3, s[12:15], s72 offen nt lds
s_waitcnt vmcnt(4)
buffer_load_dwordx4 v3, s[12:15], s72 offen offset:1024 nt lds
s_waitcnt vmcnt(4)
buffer_load_dwordx4 v3, s[12:15], s72 offen offset:2048 nt lds
s_waitcnt vmcnt(4)
buffer_load_dwordx4 v3, s[12:15], s72 offen offset:3072 nt lds
s_waitcnt vmcnt(4)
s_waitcnt vmcnt(6)
s_barrier
l1_a1:
v_readfirstlane_b32 s78, v20
s_and_b32 s78, s78, 0xff
s_cmp_lt_u32 s78, 8
s_cbranch_scc1 fw17
fb17:
v_readfirstlane_b32 s78, v21
s_and_b32 s78, s78, 0xff
s_cmp_lt_u32 s78, 8
s_cbranch_scc1 fw18
fb18:
s_mov_b32 s71, 0
lp_loop:
s_bfe_u32 s78, s71, 0x10004
s_lshr_b32 s79, s71, 5
s_lshl_b32 s78, s78, 2
s_lshl_b32 s79, s79, 1
s_or_b32 s70, s78, s79
s_add_u32 s79, s59, s71
s_and_b32 s79, s79, 12
s_lshl_b32 s79, s79, 2
s_or_b32 s79, s79, s70
s_lshl_b32 s72, s79, 17
s_add_u32 s76, s72, s80
s_lshl_b32 s72, s79, 14
s_add_u32 s73, s72, s81
s_add_u32 m0, s75, 0
s_add_u32 s72, s76, 0
buffer_load_dwordx4 v13, s[24:27], s72 offen lds
buffer_load_dwordx4 v14, s[24:27], s72 offen offset:1024 lds
s_add_u32 m0, s74, 65536
s_add_u32 s72, s73, 0
buffer_load_dwordx4 v12, s[20:23], s72 offen sc1 lds
buffer_load_dwordx4 v12, s[20:23], s72 offen offset:1024 sc1 lds
buffer_load_dwordx4 v12, s[20:23], s72 offen offset:2048 sc1 lds
buffer_load_dwordx4 v12, s[20:23], s72 offen offset:3072 sc1 lds
s_waitcnt vmcnt(6)
s_barrier
s_add_u32 m0, s75, 16384
s_add_u32 s72, s76, 131072
buffer_load_dwordx4 v13, s[24:27], s72 offen lds
buffer_load_dwordx4 v14, s[24:27], s72 offen offset:1024 lds
s_add_u32 m0, s74, 81920
s_add_u32 s72, s73, 4096
buffer_load_dwordx4 v12, s[20:23], s72 offen sc1 lds
buffer_load_dwordx4 v12, s[20:23], s72 offen offset:1024 sc1 lds
buffer_load_dwordx4 v12, s[20:23], s72 offen offset:2048 sc1 lds
buffer_load_dwordx4 v12, s[20:23], s72 offen offset:3072 sc1 lds
s_cmp_eq_u32 s71, 28
s_cbranch_scc1 lp_fl
s_waitcnt vmcnt(6)
lp_fb:
s_barrier
s_add_u32 m0, s75, 32768
s_add_u32 s72, s76, 1048576
buffer_load_dwordx4 v13, s[24:27], s72 offen lds
buffer_load_dwordx4 v14, s[24:27], s72 offen offset:1024 lds
s_add_u32 m0, s74, 98304
s_add_u32 s72, s73, 131072
buffer_load_dwordx4 v12, s[20:23], s72 offen sc1 lds
buffer_load_dwordx4 v12, s[20:23], s72 offen offset:1024 sc1 lds
buffer_load_dwordx4 v12, s[20:23], s72 offen offset:2048 sc1 lds
buffer_load_dwordx4 v12, s[20:23], s72 offen offset:3072 sc1 lds
s_cmp_eq_u32 s71, 0
s_cbranch_scc1 lp_t2
s_waitcnt vmcnt(6)
lp_tb2:
s_barrier
s_add_u32 m0, s75, 49152
s_add_u32 s72, s76, 1179648
buffer_load_dwordx4 v13, s[24:27], s72 offen lds
buffer_load_dwordx4 v14, s[24:27], s72 offen offset:1024 lds
s_add_u32 m0, s74, 114688
s_add_u32 s72, s73, 135168
buffer_load_dwordx4 v12, s[20:23], s72 offen sc1 lds
buffer_load_dwordx4 v12, s[20:23], s72 offen offset:1024 sc1 lds
buffer_load_dwordx4 v12, s[20:23], s72 offen offset:2048 sc1 lds
buffer_load_dwordx4 v12, s[20:23], s72 offen offset:3072 sc1 lds
s_waitcnt vmcnt(6)
s_barrier
s_add_u32 s71, s71, 4
s_cmp_lg_u32 s71, 32
s_cbranch_scc1 lp_nx
v_readfirstlane_b32 s78, v22
s_and_b32 s78, s78, 0xff
s_cmp_lt_u32 s78, 8
s_cbranch_scc1 fw19
fb19:
v_readfirstlane_b32 s78, v23
s_and_b32 s78, s78, 0xff
s_cmp_lt_u32 s78, 8
s_cbranch_scc1 fw20
fb20:
lp_nx:
s_cmp_lt_u32 s71, 64
s_cbranch_scc1 lp_loop
s_waitcnt vmcnt(0)
s_barrier
s_barrier
s_branch concat_heads__mha_block_cached__mha_block_cached__near_ridge_kernel_fin
c1_start:
s_and_b32 s77, s2, 7
s_lshr_b32 s78, s2, 3
s_bfe_u32 s58, s77, 0x10001
s_lshl_b32 s58, s58, 2
s_lshr_b32 s79, s78, 3
s_add_u32 s58, s58, s79
s_and_b32 s80, s77, 1
s_lshl_b32 s80, s80, 3
s_and_b32 s72, s78, 7
s_add_u32 s80, s80, s72
s_lshr_b32 s72, s72, 1
s_add_u32 s59, s79, s72
s_and_b32 s59, s59, 3
s_lshl_b32 s59, s59, 2
s_mov_b32 s62, 0
s_and_b32 s63, s78, 1
s_setprio 1
s_cmp_eq_u32 s63, 0
s_mov_b32 s77, 157763
s_cselect_b32 s69, 157763, s77
s_mov_b32 s60, 1
s_mov_b32 s61, 11
v_bfe_u32 v6, v0, 0, 5
v_bfe_u32 v7, v0, 5, 1
v_bfe_u32 v8, v0, 0, 4
v_xor_b32 v8, v8, v7
v_lshlrev_b32 v8, 4, v8
v_lshl_add_u32 v10, v6, 8, v8
v_xor_b32 v11, 32, v10
v_xor_b32 v12, 64, v10
v_xor_b32 v13, 96, v10
v_xor_b32 v14, 128, v10
v_xor_b32 v15, 160, v10
v_xor_b32 v16, 192, v10
v_xor_b32 v17, 224, v10
v_bfe_u32 v6, v0, 2, 2
v_bfe_u32 v8, v0, 1, 1
v_bfe_u32 v9, v0, 0, 1
v_lshlrev_b32 v9, 3, v9
v_bfe_u32 v4, v0, 4, 1
v_lshl_add_u32 v5, v4, 1, v8
v_lshlrev_b32 v2, 2, v6
v_xor_b32 v5, v5, v2
v_lshl_add_u32 v5, v5, 4, v9
v_lshl_add_u32 v2, v7, 2, v6
v_lshl_add_u32 v5, v2, 8, v5
v_add_u32 v18, 0x10000, v5
v_xor_b32 v19, 64, v18
v_xor_b32 v20, 128, v18
v_xor_b32 v21, 192, v18
v_bfe_u32 v3, v0, 4, 2
v_lshl_or_b32 v5, v4, 2, v6
v_lshlrev_b32 v5, 1, v5
v_xor_b32 v5, v5, v8
v_lshl_add_u32 v5, v5, 4, v9
v_lshl_add_u32 v2, v3, 3, v6
v_lshl_add_u32 v22, v2, 8, v5
v_xor_b32 v23, 32, v22
v_xor_b32 v24, 64, v22
v_xor_b32 v25, 96, v22
v_xor_b32 v26, 128, v22
v_xor_b32 v27, 160, v22
v_xor_b32 v28, 192, v22
v_xor_b32 v29, 224, v22
v_bfe_u32 v6, v0, 0, 4
v_bfe_u32 v8, v0, 1, 3
v_xor_b32 v8, v8, v3
v_lshlrev_b32 v8, 4, v8
v_lshl_add_u32 v8, v6, 7, v8
s_lshl_b32 s77, s64, 12
s_add_u32 s77, s77, 0x10000
v_add_u32 v30, s77, v8
v_xor_b32 v31, 64, v30
v_lshlrev_b32 v1, 4, v0
s_cmp_eq_u32 s67, 0
s_waitcnt lgkmcnt(0)
s_mov_b32 s20, s54
s_mov_b32 s21, s55
s_mov_b32 s22, 16777216
s_mov_b32 s23, 0x20000
s_mov_b32 s28, s52
s_mov_b32 s29, s53
s_mov_b32 s30, 4194304
s_mov_b32 s31, 0x20000
s_branch c1_disp
c1_next:
c1_disp:
s_and_b32 s77, s69, 7
s_bfe_u32 s70, s69, 0x10003
s_bfe_u32 s79, s69, 0x10004
s_lshr_b32 s69, s69, 5
s_cmp_eq_u32 s77, 2
s_cbranch_scc1 c1_a
s_cmp_eq_u32 s77, 3
s_cbranch_scc1 c1_qj
c1_p:
s_lshl_b32 s71, s70, 3
s_lshl_b32 s79, s79, 3
s_sub_u32 s76, 16, s79
s_cmp_eq_u32 s79, 0
s_cbranch_scc1 c1_p0
v_mov_b32 v96, v128
v_mov_b32 v97, v129
v_mov_b32 v98, v130
v_mov_b32 v99, v131
v_mov_b32 v100, v132
v_mov_b32 v101, v133
v_mov_b32 v102, v134
v_mov_b32 v103, v135
v_mov_b32 v104, v136
v_mov_b32 v105, v137
v_mov_b32 v106, v138
v_mov_b32 v107, v139
v_mov_b32 v108, v140
v_mov_b32 v109, v141
v_mov_b32 v110, v142
v_mov_b32 v111, v143
v_mov_b32 v112, v144
v_mov_b32 v113, v145
v_mov_b32 v114, v146
v_mov_b32 v115, v147
v_mov_b32 v116, v148
v_mov_b32 v117, v149
v_mov_b32 v118, v150
v_mov_b32 v119, v151
v_mov_b32 v120, v152
v_mov_b32 v121, v153
v_mov_b32 v122, v154
v_mov_b32 v123, v155
v_mov_b32 v124, v156
v_mov_b32 v125, v157
v_mov_b32 v126, v158
v_mov_b32 v127, v159
c1_p0:
v_bfe_u32 v6, v0, 0, 4
v_bfe_u32 v7, v0, 4, 1
v_bfe_u32 v8, v0, 5, 1
s_lshr_b32 s77, s64, 1
s_and_b32 s78, s64, 1
s_lshl_b32 s79, s77, 13
s_add_u32 s79, s79, 0x10000
v_lshl_add_u32 v9, v7, 5, v6
v_lshlrev_b32 v9, 4, v9
v_lshl_add_u32 v9, v8, 10, v9
v_add_u32 v248, s79, v9
s_lshl_b32 s79, s77, 18
s_lshl_b32 s72, s78, 6
s_add_u32 s79, s79, s72
v_lshlrev_b32 v251, 12, v6
v_lshl_add_u32 v251, v7, 5, v251
v_lshl_add_u32 v251, v8, 4, v251
v_add_u32 v251, s79, v251
v_bfe_u32 v6, v0, 2, 2
v_bfe_u32 v4, v0, 1, 1
v_bfe_u32 v5, v0, 0, 1
v_bfe_u32 v2, v0, 3, 2
v_lshl_add_u32 v7, v7, 2, v6
v_lshl_add_u32 v7, v8, 4, v7
v_lshlrev_b32 v2, 1, v2
v_xor_b32 v2, v2, v4
v_lshlrev_b32 v2, 4, v2
v_lshl_add_u32 v2, v5, 3, v2
v_lshl_add_u32 v2, v7, 7, v2
v_xor_b32 v249, s72, v2
v_xor_b32 v250, 32, v249
ds_read_b64_tr_b16 v[176:177], v249 offset:0
ds_read_b64_tr_b16 v[178:179], v249 offset:1024
ds_read_b128 v[216:219], v248 offset:0
ds_read_b64_tr_b16 v[180:181], v250 offset:0
ds_read_b64_tr_b16 v[182:183], v250 offset:1024
ds_read_b128 v[220:223], v248 offset:256
ds_read_b128 v[224:227], v248 offset:4096
ds_read_b128 v[228:231], v248 offset:4352
s_cmp_lg_u32 s70, 0
s_cbranch_scc1 c2_loop
v_mov_b32 v128, 0
v_mov_b32 v129, 0
v_mov_b32 v130, 0
v_mov_b32 v131, 0
v_mov_b32 v132, 0
v_mov_b32 v133, 0
v_mov_b32 v134, 0
v_mov_b32 v135, 0
v_mov_b32 v136, 0
v_mov_b32 v137, 0
v_mov_b32 v138, 0
v_mov_b32 v139, 0
v_mov_b32 v140, 0
v_mov_b32 v141, 0
v_mov_b32 v142, 0
v_mov_b32 v143, 0
v_mov_b32 v144, 0
v_mov_b32 v145, 0
v_mov_b32 v146, 0
v_mov_b32 v147, 0
v_mov_b32 v148, 0
v_mov_b32 v149, 0
v_mov_b32 v150, 0
v_mov_b32 v151, 0
v_mov_b32 v152, 0
v_mov_b32 v153, 0
v_mov_b32 v154, 0
v_mov_b32 v155, 0
v_mov_b32 v156, 0
v_mov_b32 v157, 0
v_mov_b32 v158, 0
v_mov_b32 v159, 0
c2_loop:
s_waitcnt lgkmcnt(5)
v_mfma_f32_16x16x32_bf16 v[128:131], v[176:179], v[216:219], v[128:131]
ds_read_b64_tr_b16 v[184:185], v249 offset:4096
s_waitcnt lgkmcnt(4)
v_mfma_f32_16x16x32_bf16 v[132:135], v[180:183], v[216:219], v[132:135]
ds_read_b64_tr_b16 v[186:187], v249 offset:5120
s_waitcnt lgkmcnt(4)
v_mfma_f32_16x16x32_bf16 v[136:139], v[176:179], v[220:223], v[136:139]
ds_read_b128 v[232:235], v248 offset:2048
v_mfma_f32_16x16x32_bf16 v[140:143], v[180:183], v[220:223], v[140:143]
ds_read_b64_tr_b16 v[188:189], v250 offset:4096
s_waitcnt lgkmcnt(5)
v_mfma_f32_16x16x32_bf16 v[144:147], v[176:179], v[224:227], v[144:147]
ds_read_b64_tr_b16 v[190:191], v250 offset:5120
v_mfma_f32_16x16x32_bf16 v[148:151], v[180:183], v[224:227], v[148:151]
ds_read_b128 v[236:239], v248 offset:2304
s_waitcnt lgkmcnt(6)
v_mfma_f32_16x16x32_bf16 v[152:155], v[176:179], v[228:231], v[152:155]
ds_read_b128 v[240:243], v248 offset:6144
v_mfma_f32_16x16x32_bf16 v[156:159], v[180:183], v[228:231], v[156:159]
ds_read_b128 v[244:247], v248 offset:6400
s_waitcnt lgkmcnt(5)
v_mfma_f32_16x16x32_bf16 v[128:131], v[184:187], v[232:235], v[128:131]
s_barrier
ds_read_b64_tr_b16 v[176:177], v249 offset:16384
s_waitcnt lgkmcnt(4)
v_mfma_f32_16x16x32_bf16 v[132:135], v[188:191], v[232:235], v[132:135]
ds_read_b64_tr_b16 v[178:179], v249 offset:17408
s_waitcnt lgkmcnt(4)
v_mfma_f32_16x16x32_bf16 v[136:139], v[184:187], v[236:239], v[136:139]
ds_read_b128 v[216:219], v248 offset:16384
v_mfma_f32_16x16x32_bf16 v[140:143], v[188:191], v[236:239], v[140:143]
ds_read_b64_tr_b16 v[180:181], v250 offset:16384
s_waitcnt lgkmcnt(5)
v_mfma_f32_16x16x32_bf16 v[144:147], v[184:187], v[240:243], v[144:147]
ds_read_b64_tr_b16 v[182:183], v250 offset:17408
v_mfma_f32_16x16x32_bf16 v[148:151], v[188:191], v[240:243], v[148:151]
ds_read_b128 v[220:223], v248 offset:16640
s_waitcnt lgkmcnt(6)
v_mfma_f32_16x16x32_bf16 v[152:155], v[184:187], v[244:247], v[152:155]
ds_read_b128 v[224:227], v248 offset:20480
v_mfma_f32_16x16x32_bf16 v[156:159], v[188:191], v[244:247], v[156:159]
ds_read_b128 v[228:231], v248 offset:20736
s_waitcnt lgkmcnt(5)
v_mfma_f32_16x16x32_bf16 v[128:131], v[176:179], v[216:219], v[128:131]
ds_read_b64_tr_b16 v[184:185], v249 offset:20480
s_waitcnt lgkmcnt(4)
v_mfma_f32_16x16x32_bf16 v[132:135], v[180:183], v[216:219], v[132:135]
ds_read_b64_tr_b16 v[186:187], v249 offset:21504
s_waitcnt lgkmcnt(4)
v_mfma_f32_16x16x32_bf16 v[136:139], v[176:179], v[220:223], v[136:139]
ds_read_b128 v[232:235], v248 offset:18432
v_mfma_f32_16x16x32_bf16 v[140:143], v[180:183], v[220:223], v[140:143]
ds_read_b64_tr_b16 v[188:189], v250 offset:20480
s_waitcnt lgkmcnt(5)
v_mfma_f32_16x16x32_bf16 v[144:147], v[176:179], v[224:227], v[144:147]
ds_read_b64_tr_b16 v[190:191], v250 offset:21504
v_mfma_f32_16x16x32_bf16 v[148:151], v[180:183], v[224:227], v[148:151]
ds_read_b128 v[236:239], v248 offset:18688
s_waitcnt lgkmcnt(6)
v_mfma_f32_16x16x32_bf16 v[152:155], v[176:179], v[228:231], v[152:155]
ds_read_b128 v[240:243], v248 offset:22528
v_mfma_f32_16x16x32_bf16 v[156:159], v[180:183], v[228:231], v[156:159]
ds_read_b128 v[244:247], v248 offset:22784
s_waitcnt lgkmcnt(5)
v_mfma_f32_16x16x32_bf16 v[128:131], v[184:187], v[232:235], v[128:131]
s_barrier
ds_read_b64_tr_b16 v[176:177], v249 offset:32768
s_waitcnt lgkmcnt(4)
v_mfma_f32_16x16x32_bf16 v[132:135], v[188:191], v[232:235], v[132:135]
ds_read_b64_tr_b16 v[178:179], v249 offset:33792
s_waitcnt lgkmcnt(4)
v_mfma_f32_16x16x32_bf16 v[136:139], v[184:187], v[236:239], v[136:139]
ds_read_b128 v[216:219], v248 offset:32768
v_mfma_f32_16x16x32_bf16 v[140:143], v[188:191], v[236:239], v[140:143]
ds_read_b64_tr_b16 v[180:181], v250 offset:32768
s_waitcnt lgkmcnt(5)
v_mfma_f32_16x16x32_bf16 v[144:147], v[184:187], v[240:243], v[144:147]
ds_read_b64_tr_b16 v[182:183], v250 offset:33792
v_mfma_f32_16x16x32_bf16 v[148:151], v[188:191], v[240:243], v[148:151]
ds_read_b128 v[220:223], v248 offset:33024
s_waitcnt lgkmcnt(6)
v_mfma_f32_16x16x32_bf16 v[152:155], v[184:187], v[244:247], v[152:155]
ds_read_b128 v[224:227], v248 offset:36864
v_mfma_f32_16x16x32_bf16 v[156:159], v[188:191], v[244:247], v[156:159]
ds_read_b128 v[228:231], v248 offset:37120
s_waitcnt lgkmcnt(5)
v_mfma_f32_16x16x32_bf16 v[128:131], v[176:179], v[216:219], v[128:131]
ds_read_b64_tr_b16 v[184:185], v249 offset:36864
s_waitcnt lgkmcnt(4)
v_mfma_f32_16x16x32_bf16 v[132:135], v[180:183], v[216:219], v[132:135]
ds_read_b64_tr_b16 v[186:187], v249 offset:37888
s_waitcnt lgkmcnt(4)
v_mfma_f32_16x16x32_bf16 v[136:139], v[176:179], v[220:223], v[136:139]
ds_read_b128 v[232:235], v248 offset:34816
v_mfma_f32_16x16x32_bf16 v[140:143], v[180:183], v[220:223], v[140:143]
ds_read_b64_tr_b16 v[188:189], v250 offset:36864
s_waitcnt lgkmcnt(5)
v_mfma_f32_16x16x32_bf16 v[144:147], v[176:179], v[224:227], v[144:147]
ds_read_b64_tr_b16 v[190:191], v250 offset:37888
v_mfma_f32_16x16x32_bf16 v[148:151], v[180:183], v[224:227], v[148:151]
ds_read_b128 v[236:239], v248 offset:35072
s_waitcnt lgkmcnt(6)
v_mfma_f32_16x16x32_bf16 v[152:155], v[176:179], v[228:231], v[152:155]
ds_read_b128 v[240:243], v248 offset:38912
v_mfma_f32_16x16x32_bf16 v[156:159], v[180:183], v[228:231], v[156:159]
ds_read_b128 v[244:247], v248 offset:39168
s_waitcnt lgkmcnt(5)
v_mfma_f32_16x16x32_bf16 v[128:131], v[184:187], v[232:235], v[128:131]
s_barrier
ds_read_b64_tr_b16 v[176:177], v249 offset:49152
s_waitcnt lgkmcnt(4)
v_mfma_f32_16x16x32_bf16 v[132:135], v[188:191], v[232:235], v[132:135]
ds_read_b64_tr_b16 v[178:179], v249 offset:50176
s_waitcnt lgkmcnt(4)
v_mfma_f32_16x16x32_bf16 v[136:139], v[184:187], v[236:239], v[136:139]
ds_read_b128 v[216:219], v248 offset:49152
v_mfma_f32_16x16x32_bf16 v[140:143], v[188:191], v[236:239], v[140:143]
ds_read_b64_tr_b16 v[180:181], v250 offset:49152
s_waitcnt lgkmcnt(5)
v_mfma_f32_16x16x32_bf16 v[144:147], v[184:187], v[240:243], v[144:147]
ds_read_b64_tr_b16 v[182:183], v250 offset:50176
v_mfma_f32_16x16x32_bf16 v[148:151], v[188:191], v[240:243], v[148:151]
ds_read_b128 v[220:223], v248 offset:49408
s_waitcnt lgkmcnt(6)
v_mfma_f32_16x16x32_bf16 v[152:155], v[184:187], v[244:247], v[152:155]
ds_read_b128 v[224:227], v248 offset:53248
v_mfma_f32_16x16x32_bf16 v[156:159], v[188:191], v[244:247], v[156:159]
ds_read_b128 v[228:231], v248 offset:53504
s_waitcnt lgkmcnt(5)
v_mfma_f32_16x16x32_bf16 v[128:131], v[176:179], v[216:219], v[128:131]
ds_read_b64_tr_b16 v[184:185], v249 offset:53248
s_waitcnt lgkmcnt(4)
v_mfma_f32_16x16x32_bf16 v[132:135], v[180:183], v[216:219], v[132:135]
ds_read_b64_tr_b16 v[186:187], v249 offset:54272
s_waitcnt lgkmcnt(4)
v_mfma_f32_16x16x32_bf16 v[136:139], v[176:179], v[220:223], v[136:139]
ds_read_b128 v[232:235], v248 offset:51200
v_mfma_f32_16x16x32_bf16 v[140:143], v[180:183], v[220:223], v[140:143]
ds_read_b64_tr_b16 v[188:189], v250 offset:53248
s_waitcnt lgkmcnt(5)
v_mfma_f32_16x16x32_bf16 v[144:147], v[176:179], v[224:227], v[144:147]
ds_read_b64_tr_b16 v[190:191], v250 offset:54272
v_mfma_f32_16x16x32_bf16 v[148:151], v[180:183], v[224:227], v[148:151]
ds_read_b128 v[236:239], v248 offset:51456
s_waitcnt lgkmcnt(6)
v_mfma_f32_16x16x32_bf16 v[152:155], v[176:179], v[228:231], v[152:155]
ds_read_b128 v[240:243], v248 offset:55296
v_mfma_f32_16x16x32_bf16 v[156:159], v[180:183], v[228:231], v[156:159]
ds_read_b128 v[244:247], v248 offset:55552
s_waitcnt lgkmcnt(5)
v_mfma_f32_16x16x32_bf16 v[128:131], v[184:187], v[232:235], v[128:131]
s_waitcnt vmcnt(0)
s_barrier
s_cmp_lg_u32 s62, 0
s_cbranch_scc1 sg21
sb21:
ds_read_b64_tr_b16 v[176:177], v249 offset:0
s_waitcnt lgkmcnt(4)
v_mfma_f32_16x16x32_bf16 v[132:135], v[188:191], v[232:235], v[132:135]
ds_read_b64_tr_b16 v[178:179], v249 offset:1024
s_waitcnt lgkmcnt(4)
v_mfma_f32_16x16x32_bf16 v[136:139], v[184:187], v[236:239], v[136:139]
ds_read_b128 v[216:219], v248 offset:0
v_mfma_f32_16x16x32_bf16 v[140:143], v[188:191], v[236:239], v[140:143]
ds_read_b64_tr_b16 v[180:181], v250 offset:0
s_waitcnt lgkmcnt(5)
v_mfma_f32_16x16x32_bf16 v[144:147], v[184:187], v[240:243], v[144:147]
ds_read_b64_tr_b16 v[182:183], v250 offset:1024
v_mfma_f32_16x16x32_bf16 v[148:151], v[188:191], v[240:243], v[148:151]
ds_read_b128 v[220:223], v248 offset:256
s_waitcnt lgkmcnt(6)
v_mfma_f32_16x16x32_bf16 v[152:155], v[184:187], v[244:247], v[152:155]
ds_read_b128 v[224:227], v248 offset:4096
v_mfma_f32_16x16x32_bf16 v[156:159], v[188:191], v[244:247], v[156:159]
ds_read_b128 v[228:231], v248 offset:4352
s_add_u32 s71, s71, 1
s_cmp_lt_u32 s71, s76
s_cbranch_scc1 c2_loop
s_waitcnt lgkmcnt(0)
s_cmp_lt_u32 s71, 16
s_cbranch_scc1 c1_next
s_lshl_b32 s72, s58, 19
s_lshl_b32 s77, s67, 11
s_add_u32 s72, s72, s77
s_lshl_b32 s77, s80, 7
s_add_u32 s72, s72, s77
s_waitcnt lgkmcnt(0)
v_cvt_pk_bf16_f32 v216, v128, v129
v_cvt_pk_bf16_f32 v217, v130, v131
v_cvt_pk_bf16_f32 v218, v132, v133
v_cvt_pk_bf16_f32 v219, v134, v135
s_nop 1
v_permlane16_swap_b32 v216, v218
v_permlane16_swap_b32 v217, v219
buffer_store_dwordx4 v[216:219], v251, s[28:31], s72 offen nt
s_add_u32 s72, s72, 0x10000
v_cvt_pk_bf16_f32 v220, v136, v137
v_cvt_pk_bf16_f32 v221, v138, v139
v_cvt_pk_bf16_f32 v222, v140, v141
v_cvt_pk_bf16_f32 v223, v142, v143
s_nop 1
v_permlane16_swap_b32 v220, v222
v_permlane16_swap_b32 v221, v223
buffer_store_dwordx4 v[220:223], v251, s[28:31], s72 offen nt
s_add_u32 s72, s72, 0x10000
v_cvt_pk_bf16_f32 v224, v144, v145
v_cvt_pk_bf16_f32 v225, v146, v147
v_cvt_pk_bf16_f32 v226, v148, v149
v_cvt_pk_bf16_f32 v227, v150, v151
s_nop 1
v_permlane16_swap_b32 v224, v226
v_permlane16_swap_b32 v225, v227
buffer_store_dwordx4 v[224:227], v251, s[28:31], s72 offen nt
s_add_u32 s72, s72, 0x10000
v_cvt_pk_bf16_f32 v228, v152, v153
v_cvt_pk_bf16_f32 v229, v154, v155
v_cvt_pk_bf16_f32 v230, v156, v157
v_cvt_pk_bf16_f32 v231, v158, v159
s_nop 1
v_permlane16_swap_b32 v228, v230
v_permlane16_swap_b32 v229, v231
buffer_store_dwordx4 v[228:231], v251, s[28:31], s72 offen nt
s_add_u32 s72, s72, 0x10000
s_branch concat_heads__mha_block_cached__mha_block_cached__near_ridge_kernel_fin
c1_qj:
v_mov_b32 v32, 0
v_mov_b32 v33, 0
v_mov_b32 v34, 0
v_mov_b32 v35, 0
v_mov_b32 v36, 0
v_mov_b32 v37, 0
v_mov_b32 v38, 0
v_mov_b32 v39, 0
v_mov_b32 v40, 0
v_mov_b32 v41, 0
v_mov_b32 v42, 0
v_mov_b32 v43, 0
v_mov_b32 v44, 0
v_mov_b32 v45, 0
v_mov_b32 v46, 0
v_mov_b32 v47, 0
v_mov_b32 v48, 0
v_mov_b32 v49, 0
v_mov_b32 v50, 0
v_mov_b32 v51, 0
v_mov_b32 v52, 0
v_mov_b32 v53, 0
v_mov_b32 v54, 0
v_mov_b32 v55, 0
v_mov_b32 v56, 0
v_mov_b32 v57, 0
v_mov_b32 v58, 0
v_mov_b32 v59, 0
v_mov_b32 v60, 0
v_mov_b32 v61, 0
v_mov_b32 v62, 0
v_mov_b32 v63, 0
v_mov_b32 v64, 0
v_mov_b32 v65, 0
v_mov_b32 v66, 0
v_mov_b32 v67, 0
v_mov_b32 v68, 0
v_mov_b32 v69, 0
v_mov_b32 v70, 0
v_mov_b32 v71, 0
v_mov_b32 v72, 0
v_mov_b32 v73, 0
v_mov_b32 v74, 0
v_mov_b32 v75, 0
v_mov_b32 v76, 0
v_mov_b32 v77, 0
v_mov_b32 v78, 0
v_mov_b32 v79, 0
v_mov_b32 v80, 0
v_mov_b32 v81, 0
v_mov_b32 v82, 0
v_mov_b32 v83, 0
v_mov_b32 v84, 0
v_mov_b32 v85, 0
v_mov_b32 v86, 0
v_mov_b32 v87, 0
v_mov_b32 v88, 0
v_mov_b32 v89, 0
v_mov_b32 v90, 0
v_mov_b32 v91, 0
v_mov_b32 v92, 0
v_mov_b32 v93, 0
v_mov_b32 v94, 0
v_mov_b32 v95, 0
v_mov_b32 v160, 0
v_mov_b32 v161, 0
v_mov_b32 v162, 0
v_mov_b32 v163, 0
v_mov_b32 v164, 0
v_mov_b32 v165, 0
v_mov_b32 v166, 0
v_mov_b32 v167, 0
v_mov_b32 v168, 0
v_mov_b32 v169, 0
v_mov_b32 v170, 0
v_mov_b32 v171, 0
v_mov_b32 v172, 0
v_mov_b32 v173, 0
v_mov_b32 v174, 0
v_mov_b32 v175, 0
v_mov_b32 v176, 0
v_mov_b32 v177, 0
v_mov_b32 v178, 0
v_mov_b32 v179, 0
v_mov_b32 v180, 0
v_mov_b32 v181, 0
v_mov_b32 v182, 0
v_mov_b32 v183, 0
v_mov_b32 v184, 0
v_mov_b32 v185, 0
v_mov_b32 v186, 0
v_mov_b32 v187, 0
v_mov_b32 v188, 0
v_mov_b32 v189, 0
v_mov_b32 v190, 0
v_mov_b32 v191, 0
v_mov_b32 v192, 0
v_mov_b32 v193, 0
v_mov_b32 v194, 0
v_mov_b32 v195, 0
v_mov_b32 v196, 0
v_mov_b32 v197, 0
v_mov_b32 v198, 0
v_mov_b32 v199, 0
v_mov_b32 v200, 0
v_mov_b32 v201, 0
v_mov_b32 v202, 0
v_mov_b32 v203, 0
v_mov_b32 v204, 0
v_mov_b32 v205, 0
v_mov_b32 v206, 0
v_mov_b32 v207, 0
v_mov_b32 v208, 0
v_mov_b32 v209, 0
v_mov_b32 v210, 0
v_mov_b32 v211, 0
v_mov_b32 v212, 0
v_mov_b32 v213, 0
v_mov_b32 v214, 0
v_mov_b32 v215, 0
v_mov_b32 v248, 0
v_mov_b32 v249, 0
v_mov_b32 v250, 0
v_mov_b32 v251, 0
v_mov_b32 v252, 0
v_mov_b32 v253, 0
v_mov_b32 v254, 0
v_mov_b32 v255, 0
s_mov_b32 s71, 0
s_cmp_eq_u32 s60, 0
s_cbranch_scc1 c1_qj_nf
s_mov_b32 s60, 0
s_barrier
s_barrier
c1_qj_nf:
ds_read_b64_tr_b16 v[216:217], v22 offset:0
ds_read_b64_tr_b16 v[218:219], v22 offset:1024
ds_read_b128 v[96:99], v30 offset:0
ds_read_b64_tr_b16 v[220:221], v23 offset:0
ds_read_b64_tr_b16 v[222:223], v23 offset:1024
ds_read_b128 v[100:103], v30 offset:2048
ds_read_b64_tr_b16 v[224:225], v24 offset:0
ds_read_b64_tr_b16 v[226:227], v24 offset:1024
ds_read_b64_tr_b16 v[228:229], v25 offset:0
ds_read_b64_tr_b16 v[230:231], v25 offset:1024
ds_read_b64_tr_b16 v[232:233], v26 offset:0
ds_read_b64_tr_b16 v[234:235], v26 offset:1024
ds_read_b64_tr_b16 v[236:237], v27 offset:0
ds_read_b64_tr_b16 v[238:239], v27 offset:1024
c1_qj_loop:
s_waitcnt lgkmcnt(8)
v_mfma_f32_16x16x32_bf16 v[32:35], v[216:219], v[96:99], v[32:35]
ds_read_b64_tr_b16 v[240:241], v28 offset:0
v_mfma_f32_16x16x32_bf16 v[36:39], v[216:219], v[100:103], v[36:39]
ds_read_b64_tr_b16 v[242:243], v28 offset:1024
v_mfma_f32_16x16x32_bf16 v[40:43], v[220:223], v[96:99], v[40:43]
ds_read_b64_tr_b16 v[244:245], v29 offset:0
v_mfma_f32_16x16x32_bf16 v[44:47], v[220:223], v[100:103], v[44:47]
ds_read_b64_tr_b16 v[246:247], v29 offset:1024
s_waitcnt lgkmcnt(8)
v_mfma_f32_16x16x32_bf16 v[48:51], v[224:227], v[96:99], v[48:51]
ds_read_b64_tr_b16 v[216:217], v22 offset:8192
v_mfma_f32_16x16x32_bf16 v[52:55], v[224:227], v[100:103], v[52:55]
ds_read_b64_tr_b16 v[218:219], v22 offset:9216
v_mfma_f32_16x16x32_bf16 v[56:59], v[228:231], v[96:99], v[56:59]
ds_read_b64_tr_b16 v[220:221], v23 offset:8192
v_mfma_f32_16x16x32_bf16 v[60:63], v[228:231], v[100:103], v[60:63]
ds_read_b64_tr_b16 v[222:223], v23 offset:9216
s_waitcnt lgkmcnt(8)
v_mfma_f32_16x16x32_bf16 v[64:67], v[232:235], v[96:99], v[64:67]
ds_read_b64_tr_b16 v[224:225], v24 offset:8192
v_mfma_f32_16x16x32_bf16 v[68:71], v[232:235], v[100:103], v[68:71]
ds_read_b64_tr_b16 v[226:227], v24 offset:9216
v_mfma_f32_16x16x32_bf16 v[72:75], v[236:239], v[96:99], v[72:75]
ds_read_b64_tr_b16 v[228:229], v25 offset:8192
v_mfma_f32_16x16x32_bf16 v[76:79], v[236:239], v[100:103], v[76:79]
ds_read_b64_tr_b16 v[230:231], v25 offset:9216
s_waitcnt lgkmcnt(8)
v_mfma_f32_16x16x32_bf16 v[80:83], v[240:243], v[96:99], v[80:83]
ds_read_b64_tr_b16 v[232:233], v26 offset:8192
v_mfma_f32_16x16x32_bf16 v[84:87], v[240:243], v[100:103], v[84:87]
ds_read_b64_tr_b16 v[234:235], v26 offset:9216
v_mfma_f32_16x16x32_bf16 v[88:91], v[244:247], v[96:99], v[88:91]
ds_read_b64_tr_b16 v[236:237], v27 offset:8192
v_mfma_f32_16x16x32_bf16 v[92:95], v[244:247], v[100:103], v[92:95]
ds_read_b64_tr_b16 v[238:239], v27 offset:9216
s_waitcnt lgkmcnt(8)
v_mfma_f32_16x16x32_bf16 v[160:163], v[216:219], v[96:99], v[160:163]
ds_read_b64_tr_b16 v[240:241], v28 offset:8192
v_mfma_f32_16x16x32_bf16 v[164:167], v[216:219], v[100:103], v[164:167]
ds_read_b64_tr_b16 v[242:243], v28 offset:9216
v_mfma_f32_16x16x32_bf16 v[168:171], v[220:223], v[96:99], v[168:171]
ds_read_b64_tr_b16 v[244:245], v29 offset:8192
v_mfma_f32_16x16x32_bf16 v[172:175], v[220:223], v[100:103], v[172:175]
ds_read_b64_tr_b16 v[246:247], v29 offset:9216
s_waitcnt lgkmcnt(8)
v_mfma_f32_16x16x32_bf16 v[176:179], v[224:227], v[96:99], v[176:179]
s_barrier
ds_read_b64_tr_b16 v[216:217], v22 offset:16384
v_mfma_f32_16x16x32_bf16 v[180:183], v[224:227], v[100:103], v[180:183]
ds_read_b64_tr_b16 v[218:219], v22 offset:17408
ds_read_b128 v[104:107], v31 offset:0
v_mfma_f32_16x16x32_bf16 v[184:187], v[228:231], v[96:99], v[184:187]
ds_read_b64_tr_b16 v[220:221], v23 offset:16384
v_mfma_f32_16x16x32_bf16 v[188:191], v[228:231], v[100:103], v[188:191]
ds_read_b64_tr_b16 v[222:223], v23 offset:17408
ds_read_b128 v[108:111], v31 offset:2048
s_waitcnt lgkmcnt(10)
v_mfma_f32_16x16x32_bf16 v[192:195], v[232:235], v[96:99], v[192:195]
ds_read_b64_tr_b16 v[224:225], v24 offset:16384
v_mfma_f32_16x16x32_bf16 v[196:199], v[232:235], v[100:103], v[196:199]
ds_read_b64_tr_b16 v[226:227], v24 offset:17408
v_mfma_f32_16x16x32_bf16 v[200:203], v[236:239], v[96:99], v[200:203]
ds_read_b64_tr_b16 v[228:229], v25 offset:16384
v_mfma_f32_16x16x32_bf16 v[204:207], v[236:239], v[100:103], v[204:207]
ds_read_b64_tr_b16 v[230:231], v25 offset:17408
s_waitcnt lgkmcnt(10)
v_mfma_f32_16x16x32_bf16 v[208:211], v[240:243], v[96:99], v[208:211]
ds_read_b64_tr_b16 v[232:233], v26 offset:16384
v_mfma_f32_16x16x32_bf16 v[212:215], v[240:243], v[100:103], v[212:215]
ds_read_b64_tr_b16 v[234:235], v26 offset:17408
v_mfma_f32_16x16x32_bf16 v[248:251], v[244:247], v[96:99], v[248:251]
ds_read_b64_tr_b16 v[236:237], v27 offset:16384
v_mfma_f32_16x16x32_bf16 v[252:255], v[244:247], v[100:103], v[252:255]
ds_read_b64_tr_b16 v[238:239], v27 offset:17408
s_waitcnt lgkmcnt(8)
v_mfma_f32_16x16x32_bf16 v[32:35], v[216:219], v[104:107], v[32:35]
ds_read_b64_tr_b16 v[240:241], v28 offset:16384
v_mfma_f32_16x16x32_bf16 v[36:39], v[216:219], v[108:111], v[36:39]
ds_read_b64_tr_b16 v[242:243], v28 offset:17408
v_mfma_f32_16x16x32_bf16 v[40:43], v[220:223], v[104:107], v[40:43]
ds_read_b64_tr_b16 v[244:245], v29 offset:16384
v_mfma_f32_16x16x32_bf16 v[44:47], v[220:223], v[108:111], v[44:47]
ds_read_b64_tr_b16 v[246:247], v29 offset:17408
s_waitcnt lgkmcnt(8)
v_mfma_f32_16x16x32_bf16 v[48:51], v[224:227], v[104:107], v[48:51]
ds_read_b64_tr_b16 v[216:217], v22 offset:24576
v_mfma_f32_16x16x32_bf16 v[52:55], v[224:227], v[108:111], v[52:55]
ds_read_b64_tr_b16 v[218:219], v22 offset:25600
v_mfma_f32_16x16x32_bf16 v[56:59], v[228:231], v[104:107], v[56:59]
ds_read_b64_tr_b16 v[220:221], v23 offset:24576
v_mfma_f32_16x16x32_bf16 v[60:63], v[228:231], v[108:111], v[60:63]
ds_read_b64_tr_b16 v[222:223], v23 offset:25600
s_waitcnt lgkmcnt(8)
v_mfma_f32_16x16x32_bf16 v[64:67], v[232:235], v[104:107], v[64:67]
ds_read_b64_tr_b16 v[224:225], v24 offset:24576
v_mfma_f32_16x16x32_bf16 v[68:71], v[232:235], v[108:111], v[68:71]
ds_read_b64_tr_b16 v[226:227], v24 offset:25600
v_mfma_f32_16x16x32_bf16 v[72:75], v[236:239], v[104:107], v[72:75]
ds_read_b64_tr_b16 v[228:229], v25 offset:24576
v_mfma_f32_16x16x32_bf16 v[76:79], v[236:239], v[108:111], v[76:79]
ds_read_b64_tr_b16 v[230:231], v25 offset:25600
s_waitcnt lgkmcnt(8)
v_mfma_f32_16x16x32_bf16 v[80:83], v[240:243], v[104:107], v[80:83]
ds_read_b64_tr_b16 v[232:233], v26 offset:24576
v_mfma_f32_16x16x32_bf16 v[84:87], v[240:243], v[108:111], v[84:87]
ds_read_b64_tr_b16 v[234:235], v26 offset:25600
v_mfma_f32_16x16x32_bf16 v[88:91], v[244:247], v[104:107], v[88:91]
ds_read_b64_tr_b16 v[236:237], v27 offset:24576
v_mfma_f32_16x16x32_bf16 v[92:95], v[244:247], v[108:111], v[92:95]
ds_read_b64_tr_b16 v[238:239], v27 offset:25600
s_waitcnt lgkmcnt(8)
v_mfma_f32_16x16x32_bf16 v[160:163], v[216:219], v[104:107], v[160:163]
ds_read_b64_tr_b16 v[240:241], v28 offset:24576
v_mfma_f32_16x16x32_bf16 v[164:167], v[216:219], v[108:111], v[164:167]
ds_read_b64_tr_b16 v[242:243], v28 offset:25600
v_mfma_f32_16x16x32_bf16 v[168:171], v[220:223], v[104:107], v[168:171]
ds_read_b64_tr_b16 v[244:245], v29 offset:24576
v_mfma_f32_16x16x32_bf16 v[172:175], v[220:223], v[108:111], v[172:175]
ds_read_b64_tr_b16 v[246:247], v29 offset:25600
s_waitcnt lgkmcnt(8)
v_mfma_f32_16x16x32_bf16 v[176:179], v[224:227], v[104:107], v[176:179]
s_waitcnt vmcnt(0)
s_barrier
ds_read_b64_tr_b16 v[216:217], v22 offset:32768
v_mfma_f32_16x16x32_bf16 v[180:183], v[224:227], v[108:111], v[180:183]
ds_read_b64_tr_b16 v[218:219], v22 offset:33792
ds_read_b128 v[96:99], v30 offset:16384
v_mfma_f32_16x16x32_bf16 v[184:187], v[228:231], v[104:107], v[184:187]
ds_read_b64_tr_b16 v[220:221], v23 offset:32768
v_mfma_f32_16x16x32_bf16 v[188:191], v[228:231], v[108:111], v[188:191]
ds_read_b64_tr_b16 v[222:223], v23 offset:33792
ds_read_b128 v[100:103], v30 offset:18432
s_waitcnt lgkmcnt(10)
v_mfma_f32_16x16x32_bf16 v[192:195], v[232:235], v[104:107], v[192:195]
ds_read_b64_tr_b16 v[224:225], v24 offset:32768
v_mfma_f32_16x16x32_bf16 v[196:199], v[232:235], v[108:111], v[196:199]
ds_read_b64_tr_b16 v[226:227], v24 offset:33792
v_mfma_f32_16x16x32_bf16 v[200:203], v[236:239], v[104:107], v[200:203]
ds_read_b64_tr_b16 v[228:229], v25 offset:32768
v_mfma_f32_16x16x32_bf16 v[204:207], v[236:239], v[108:111], v[204:207]
ds_read_b64_tr_b16 v[230:231], v25 offset:33792
s_waitcnt lgkmcnt(10)
v_mfma_f32_16x16x32_bf16 v[208:211], v[240:243], v[104:107], v[208:211]
ds_read_b64_tr_b16 v[232:233], v26 offset:32768
v_mfma_f32_16x16x32_bf16 v[212:215], v[240:243], v[108:111], v[212:215]
ds_read_b64_tr_b16 v[234:235], v26 offset:33792
v_mfma_f32_16x16x32_bf16 v[248:251], v[244:247], v[104:107], v[248:251]
ds_read_b64_tr_b16 v[236:237], v27 offset:32768
v_mfma_f32_16x16x32_bf16 v[252:255], v[244:247], v[108:111], v[252:255]
ds_read_b64_tr_b16 v[238:239], v27 offset:33792
s_waitcnt lgkmcnt(8)
v_mfma_f32_16x16x32_bf16 v[32:35], v[216:219], v[96:99], v[32:35]
ds_read_b64_tr_b16 v[240:241], v28 offset:32768
v_mfma_f32_16x16x32_bf16 v[36:39], v[216:219], v[100:103], v[36:39]
ds_read_b64_tr_b16 v[242:243], v28 offset:33792
v_mfma_f32_16x16x32_bf16 v[40:43], v[220:223], v[96:99], v[40:43]
ds_read_b64_tr_b16 v[244:245], v29 offset:32768
v_mfma_f32_16x16x32_bf16 v[44:47], v[220:223], v[100:103], v[44:47]
ds_read_b64_tr_b16 v[246:247], v29 offset:33792
s_waitcnt lgkmcnt(8)
v_mfma_f32_16x16x32_bf16 v[48:51], v[224:227], v[96:99], v[48:51]
ds_read_b64_tr_b16 v[216:217], v22 offset:40960
v_mfma_f32_16x16x32_bf16 v[52:55], v[224:227], v[100:103], v[52:55]
ds_read_b64_tr_b16 v[218:219], v22 offset:41984
v_mfma_f32_16x16x32_bf16 v[56:59], v[228:231], v[96:99], v[56:59]
ds_read_b64_tr_b16 v[220:221], v23 offset:40960
v_mfma_f32_16x16x32_bf16 v[60:63], v[228:231], v[100:103], v[60:63]
ds_read_b64_tr_b16 v[222:223], v23 offset:41984
s_waitcnt lgkmcnt(8)
v_mfma_f32_16x16x32_bf16 v[64:67], v[232:235], v[96:99], v[64:67]
ds_read_b64_tr_b16 v[224:225], v24 offset:40960
v_mfma_f32_16x16x32_bf16 v[68:71], v[232:235], v[100:103], v[68:71]
ds_read_b64_tr_b16 v[226:227], v24 offset:41984
v_mfma_f32_16x16x32_bf16 v[72:75], v[236:239], v[96:99], v[72:75]
ds_read_b64_tr_b16 v[228:229], v25 offset:40960
v_mfma_f32_16x16x32_bf16 v[76:79], v[236:239], v[100:103], v[76:79]
ds_read_b64_tr_b16 v[230:231], v25 offset:41984
s_waitcnt lgkmcnt(8)
v_mfma_f32_16x16x32_bf16 v[80:83], v[240:243], v[96:99], v[80:83]
ds_read_b64_tr_b16 v[232:233], v26 offset:40960
v_mfma_f32_16x16x32_bf16 v[84:87], v[240:243], v[100:103], v[84:87]
ds_read_b64_tr_b16 v[234:235], v26 offset:41984
v_mfma_f32_16x16x32_bf16 v[88:91], v[244:247], v[96:99], v[88:91]
ds_read_b64_tr_b16 v[236:237], v27 offset:40960
v_mfma_f32_16x16x32_bf16 v[92:95], v[244:247], v[100:103], v[92:95]
ds_read_b64_tr_b16 v[238:239], v27 offset:41984
s_waitcnt lgkmcnt(8)
v_mfma_f32_16x16x32_bf16 v[160:163], v[216:219], v[96:99], v[160:163]
ds_read_b64_tr_b16 v[240:241], v28 offset:40960
v_mfma_f32_16x16x32_bf16 v[164:167], v[216:219], v[100:103], v[164:167]
ds_read_b64_tr_b16 v[242:243], v28 offset:41984
v_mfma_f32_16x16x32_bf16 v[168:171], v[220:223], v[96:99], v[168:171]
ds_read_b64_tr_b16 v[244:245], v29 offset:40960
v_mfma_f32_16x16x32_bf16 v[172:175], v[220:223], v[100:103], v[172:175]
ds_read_b64_tr_b16 v[246:247], v29 offset:41984
s_waitcnt lgkmcnt(8)
v_mfma_f32_16x16x32_bf16 v[176:179], v[224:227], v[96:99], v[176:179]
s_barrier
ds_read_b64_tr_b16 v[216:217], v22 offset:49152
v_mfma_f32_16x16x32_bf16 v[180:183], v[224:227], v[100:103], v[180:183]
ds_read_b64_tr_b16 v[218:219], v22 offset:50176
ds_read_b128 v[104:107], v31 offset:16384
v_mfma_f32_16x16x32_bf16 v[184:187], v[228:231], v[96:99], v[184:187]
ds_read_b64_tr_b16 v[220:221], v23 offset:49152
v_mfma_f32_16x16x32_bf16 v[188:191], v[228:231], v[100:103], v[188:191]
ds_read_b64_tr_b16 v[222:223], v23 offset:50176
ds_read_b128 v[108:111], v31 offset:18432
s_waitcnt lgkmcnt(10)
v_mfma_f32_16x16x32_bf16 v[192:195], v[232:235], v[96:99], v[192:195]
ds_read_b64_tr_b16 v[224:225], v24 offset:49152
v_mfma_f32_16x16x32_bf16 v[196:199], v[232:235], v[100:103], v[196:199]
ds_read_b64_tr_b16 v[226:227], v24 offset:50176
v_mfma_f32_16x16x32_bf16 v[200:203], v[236:239], v[96:99], v[200:203]
ds_read_b64_tr_b16 v[228:229], v25 offset:49152
v_mfma_f32_16x16x32_bf16 v[204:207], v[236:239], v[100:103], v[204:207]
ds_read_b64_tr_b16 v[230:231], v25 offset:50176
s_waitcnt lgkmcnt(10)
v_mfma_f32_16x16x32_bf16 v[208:211], v[240:243], v[96:99], v[208:211]
ds_read_b64_tr_b16 v[232:233], v26 offset:49152
v_mfma_f32_16x16x32_bf16 v[212:215], v[240:243], v[100:103], v[212:215]
ds_read_b64_tr_b16 v[234:235], v26 offset:50176
v_mfma_f32_16x16x32_bf16 v[248:251], v[244:247], v[96:99], v[248:251]
ds_read_b64_tr_b16 v[236:237], v27 offset:49152
v_mfma_f32_16x16x32_bf16 v[252:255], v[244:247], v[100:103], v[252:255]
ds_read_b64_tr_b16 v[238:239], v27 offset:50176
s_waitcnt lgkmcnt(8)
v_mfma_f32_16x16x32_bf16 v[32:35], v[216:219], v[104:107], v[32:35]
ds_read_b64_tr_b16 v[240:241], v28 offset:49152
v_mfma_f32_16x16x32_bf16 v[36:39], v[216:219], v[108:111], v[36:39]
ds_read_b64_tr_b16 v[242:243], v28 offset:50176
v_mfma_f32_16x16x32_bf16 v[40:43], v[220:223], v[104:107], v[40:43]
ds_read_b64_tr_b16 v[244:245], v29 offset:49152
v_mfma_f32_16x16x32_bf16 v[44:47], v[220:223], v[108:111], v[44:47]
ds_read_b64_tr_b16 v[246:247], v29 offset:50176
s_waitcnt lgkmcnt(8)
v_mfma_f32_16x16x32_bf16 v[48:51], v[224:227], v[104:107], v[48:51]
ds_read_b64_tr_b16 v[216:217], v22 offset:57344
v_mfma_f32_16x16x32_bf16 v[52:55], v[224:227], v[108:111], v[52:55]
ds_read_b64_tr_b16 v[218:219], v22 offset:58368
v_mfma_f32_16x16x32_bf16 v[56:59], v[228:231], v[104:107], v[56:59]
ds_read_b64_tr_b16 v[220:221], v23 offset:57344
v_mfma_f32_16x16x32_bf16 v[60:63], v[228:231], v[108:111], v[60:63]
ds_read_b64_tr_b16 v[222:223], v23 offset:58368
s_waitcnt lgkmcnt(8)
v_mfma_f32_16x16x32_bf16 v[64:67], v[232:235], v[104:107], v[64:67]
ds_read_b64_tr_b16 v[224:225], v24 offset:57344
v_mfma_f32_16x16x32_bf16 v[68:71], v[232:235], v[108:111], v[68:71]
ds_read_b64_tr_b16 v[226:227], v24 offset:58368
v_mfma_f32_16x16x32_bf16 v[72:75], v[236:239], v[104:107], v[72:75]
ds_read_b64_tr_b16 v[228:229], v25 offset:57344
v_mfma_f32_16x16x32_bf16 v[76:79], v[236:239], v[108:111], v[76:79]
ds_read_b64_tr_b16 v[230:231], v25 offset:58368
s_waitcnt lgkmcnt(8)
v_mfma_f32_16x16x32_bf16 v[80:83], v[240:243], v[104:107], v[80:83]
ds_read_b64_tr_b16 v[232:233], v26 offset:57344
v_mfma_f32_16x16x32_bf16 v[84:87], v[240:243], v[108:111], v[84:87]
ds_read_b64_tr_b16 v[234:235], v26 offset:58368
v_mfma_f32_16x16x32_bf16 v[88:91], v[244:247], v[104:107], v[88:91]
ds_read_b64_tr_b16 v[236:237], v27 offset:57344
v_mfma_f32_16x16x32_bf16 v[92:95], v[244:247], v[108:111], v[92:95]
ds_read_b64_tr_b16 v[238:239], v27 offset:58368
s_waitcnt lgkmcnt(8)
v_mfma_f32_16x16x32_bf16 v[160:163], v[216:219], v[104:107], v[160:163]
ds_read_b64_tr_b16 v[240:241], v28 offset:57344
v_mfma_f32_16x16x32_bf16 v[164:167], v[216:219], v[108:111], v[164:167]
ds_read_b64_tr_b16 v[242:243], v28 offset:58368
v_mfma_f32_16x16x32_bf16 v[168:171], v[220:223], v[104:107], v[168:171]
ds_read_b64_tr_b16 v[244:245], v29 offset:57344
v_mfma_f32_16x16x32_bf16 v[172:175], v[220:223], v[108:111], v[172:175]
ds_read_b64_tr_b16 v[246:247], v29 offset:58368
s_waitcnt lgkmcnt(8)
v_mfma_f32_16x16x32_bf16 v[176:179], v[224:227], v[104:107], v[176:179]
s_barrier
ds_read_b64_tr_b16 v[216:217], v22 offset:0
v_mfma_f32_16x16x32_bf16 v[180:183], v[224:227], v[108:111], v[180:183]
ds_read_b64_tr_b16 v[218:219], v22 offset:1024
ds_read_b128 v[96:99], v30 offset:32768
v_mfma_f32_16x16x32_bf16 v[184:187], v[228:231], v[104:107], v[184:187]
ds_read_b64_tr_b16 v[220:221], v23 offset:0
v_mfma_f32_16x16x32_bf16 v[188:191], v[228:231], v[108:111], v[188:191]
ds_read_b64_tr_b16 v[222:223], v23 offset:1024
ds_read_b128 v[100:103], v30 offset:34816
s_waitcnt lgkmcnt(10)
v_mfma_f32_16x16x32_bf16 v[192:195], v[232:235], v[104:107], v[192:195]
ds_read_b64_tr_b16 v[224:225], v24 offset:0
v_mfma_f32_16x16x32_bf16 v[196:199], v[232:235], v[108:111], v[196:199]
ds_read_b64_tr_b16 v[226:227], v24 offset:1024
v_mfma_f32_16x16x32_bf16 v[200:203], v[236:239], v[104:107], v[200:203]
ds_read_b64_tr_b16 v[228:229], v25 offset:0
v_mfma_f32_16x16x32_bf16 v[204:207], v[236:239], v[108:111], v[204:207]
ds_read_b64_tr_b16 v[230:231], v25 offset:1024
s_waitcnt lgkmcnt(10)
v_mfma_f32_16x16x32_bf16 v[208:211], v[240:243], v[104:107], v[208:211]
ds_read_b64_tr_b16 v[232:233], v26 offset:0
v_mfma_f32_16x16x32_bf16 v[212:215], v[240:243], v[108:111], v[212:215]
ds_read_b64_tr_b16 v[234:235], v26 offset:1024
v_mfma_f32_16x16x32_bf16 v[248:251], v[244:247], v[104:107], v[248:251]
ds_read_b64_tr_b16 v[236:237], v27 offset:0
v_mfma_f32_16x16x32_bf16 v[252:255], v[244:247], v[108:111], v[252:255]
ds_read_b64_tr_b16 v[238:239], v27 offset:1024
s_waitcnt lgkmcnt(8)
v_mfma_f32_16x16x32_bf16 v[32:35], v[216:219], v[96:99], v[32:35]
ds_read_b64_tr_b16 v[240:241], v28 offset:0
v_mfma_f32_16x16x32_bf16 v[36:39], v[216:219], v[100:103], v[36:39]
ds_read_b64_tr_b16 v[242:243], v28 offset:1024
v_mfma_f32_16x16x32_bf16 v[40:43], v[220:223], v[96:99], v[40:43]
ds_read_b64_tr_b16 v[244:245], v29 offset:0
v_mfma_f32_16x16x32_bf16 v[44:47], v[220:223], v[100:103], v[44:47]
ds_read_b64_tr_b16 v[246:247], v29 offset:1024
s_waitcnt lgkmcnt(8)
v_mfma_f32_16x16x32_bf16 v[48:51], v[224:227], v[96:99], v[48:51]
ds_read_b64_tr_b16 v[216:217], v22 offset:8192
v_mfma_f32_16x16x32_bf16 v[52:55], v[224:227], v[100:103], v[52:55]
ds_read_b64_tr_b16 v[218:219], v22 offset:9216
v_mfma_f32_16x16x32_bf16 v[56:59], v[228:231], v[96:99], v[56:59]
ds_read_b64_tr_b16 v[220:221], v23 offset:8192
v_mfma_f32_16x16x32_bf16 v[60:63], v[228:231], v[100:103], v[60:63]
ds_read_b64_tr_b16 v[222:223], v23 offset:9216
s_waitcnt lgkmcnt(8)
v_mfma_f32_16x16x32_bf16 v[64:67], v[232:235], v[96:99], v[64:67]
ds_read_b64_tr_b16 v[224:225], v24 offset:8192
v_mfma_f32_16x16x32_bf16 v[68:71], v[232:235], v[100:103], v[68:71]
ds_read_b64_tr_b16 v[226:227], v24 offset:9216
v_mfma_f32_16x16x32_bf16 v[72:75], v[236:239], v[96:99], v[72:75]
ds_read_b64_tr_b16 v[228:229], v25 offset:8192
v_mfma_f32_16x16x32_bf16 v[76:79], v[236:239], v[100:103], v[76:79]
ds_read_b64_tr_b16 v[230:231], v25 offset:9216
s_waitcnt lgkmcnt(8)
v_mfma_f32_16x16x32_bf16 v[80:83], v[240:243], v[96:99], v[80:83]
ds_read_b64_tr_b16 v[232:233], v26 offset:8192
v_mfma_f32_16x16x32_bf16 v[84:87], v[240:243], v[100:103], v[84:87]
ds_read_b64_tr_b16 v[234:235], v26 offset:9216
v_mfma_f32_16x16x32_bf16 v[88:91], v[244:247], v[96:99], v[88:91]
ds_read_b64_tr_b16 v[236:237], v27 offset:8192
v_mfma_f32_16x16x32_bf16 v[92:95], v[244:247], v[100:103], v[92:95]
ds_read_b64_tr_b16 v[238:239], v27 offset:9216
s_waitcnt lgkmcnt(8)
v_mfma_f32_16x16x32_bf16 v[160:163], v[216:219], v[96:99], v[160:163]
ds_read_b64_tr_b16 v[240:241], v28 offset:8192
v_mfma_f32_16x16x32_bf16 v[164:167], v[216:219], v[100:103], v[164:167]
ds_read_b64_tr_b16 v[242:243], v28 offset:9216
v_mfma_f32_16x16x32_bf16 v[168:171], v[220:223], v[96:99], v[168:171]
ds_read_b64_tr_b16 v[244:245], v29 offset:8192
v_mfma_f32_16x16x32_bf16 v[172:175], v[220:223], v[100:103], v[172:175]
ds_read_b64_tr_b16 v[246:247], v29 offset:9216
s_waitcnt lgkmcnt(8)
v_mfma_f32_16x16x32_bf16 v[176:179], v[224:227], v[96:99], v[176:179]
s_barrier
ds_read_b64_tr_b16 v[216:217], v22 offset:16384
v_mfma_f32_16x16x32_bf16 v[180:183], v[224:227], v[100:103], v[180:183]
ds_read_b64_tr_b16 v[218:219], v22 offset:17408
ds_read_b128 v[104:107], v31 offset:32768
v_mfma_f32_16x16x32_bf16 v[184:187], v[228:231], v[96:99], v[184:187]
ds_read_b64_tr_b16 v[220:221], v23 offset:16384
v_mfma_f32_16x16x32_bf16 v[188:191], v[228:231], v[100:103], v[188:191]
ds_read_b64_tr_b16 v[222:223], v23 offset:17408
ds_read_b128 v[108:111], v31 offset:34816
s_waitcnt lgkmcnt(10)
v_mfma_f32_16x16x32_bf16 v[192:195], v[232:235], v[96:99], v[192:195]
ds_read_b64_tr_b16 v[224:225], v24 offset:16384
v_mfma_f32_16x16x32_bf16 v[196:199], v[232:235], v[100:103], v[196:199]
ds_read_b64_tr_b16 v[226:227], v24 offset:17408
v_mfma_f32_16x16x32_bf16 v[200:203], v[236:239], v[96:99], v[200:203]
ds_read_b64_tr_b16 v[228:229], v25 offset:16384
v_mfma_f32_16x16x32_bf16 v[204:207], v[236:239], v[100:103], v[204:207]
ds_read_b64_tr_b16 v[230:231], v25 offset:17408
s_waitcnt lgkmcnt(10)
v_mfma_f32_16x16x32_bf16 v[208:211], v[240:243], v[96:99], v[208:211]
ds_read_b64_tr_b16 v[232:233], v26 offset:16384
v_mfma_f32_16x16x32_bf16 v[212:215], v[240:243], v[100:103], v[212:215]
ds_read_b64_tr_b16 v[234:235], v26 offset:17408
v_mfma_f32_16x16x32_bf16 v[248:251], v[244:247], v[96:99], v[248:251]
ds_read_b64_tr_b16 v[236:237], v27 offset:16384
v_mfma_f32_16x16x32_bf16 v[252:255], v[244:247], v[100:103], v[252:255]
ds_read_b64_tr_b16 v[238:239], v27 offset:17408
s_waitcnt lgkmcnt(8)
v_mfma_f32_16x16x32_bf16 v[32:35], v[216:219], v[104:107], v[32:35]
ds_read_b64_tr_b16 v[240:241], v28 offset:16384
v_mfma_f32_16x16x32_bf16 v[36:39], v[216:219], v[108:111], v[36:39]
ds_read_b64_tr_b16 v[242:243], v28 offset:17408
v_mfma_f32_16x16x32_bf16 v[40:43], v[220:223], v[104:107], v[40:43]
ds_read_b64_tr_b16 v[244:245], v29 offset:16384
v_mfma_f32_16x16x32_bf16 v[44:47], v[220:223], v[108:111], v[44:47]
ds_read_b64_tr_b16 v[246:247], v29 offset:17408
s_waitcnt lgkmcnt(8)
v_mfma_f32_16x16x32_bf16 v[48:51], v[224:227], v[104:107], v[48:51]
ds_read_b64_tr_b16 v[216:217], v22 offset:24576
v_mfma_f32_16x16x32_bf16 v[52:55], v[224:227], v[108:111], v[52:55]
ds_read_b64_tr_b16 v[218:219], v22 offset:25600
v_mfma_f32_16x16x32_bf16 v[56:59], v[228:231], v[104:107], v[56:59]
ds_read_b64_tr_b16 v[220:221], v23 offset:24576
v_mfma_f32_16x16x32_bf16 v[60:63], v[228:231], v[108:111], v[60:63]
ds_read_b64_tr_b16 v[222:223], v23 offset:25600
s_waitcnt lgkmcnt(8)
v_mfma_f32_16x16x32_bf16 v[64:67], v[232:235], v[104:107], v[64:67]
ds_read_b64_tr_b16 v[224:225], v24 offset:24576
v_mfma_f32_16x16x32_bf16 v[68:71], v[232:235], v[108:111], v[68:71]
ds_read_b64_tr_b16 v[226:227], v24 offset:25600
v_mfma_f32_16x16x32_bf16 v[72:75], v[236:239], v[104:107], v[72:75]
ds_read_b64_tr_b16 v[228:229], v25 offset:24576
v_mfma_f32_16x16x32_bf16 v[76:79], v[236:239], v[108:111], v[76:79]
ds_read_b64_tr_b16 v[230:231], v25 offset:25600
s_waitcnt lgkmcnt(8)
v_mfma_f32_16x16x32_bf16 v[80:83], v[240:243], v[104:107], v[80:83]
ds_read_b64_tr_b16 v[232:233], v26 offset:24576
v_mfma_f32_16x16x32_bf16 v[84:87], v[240:243], v[108:111], v[84:87]
ds_read_b64_tr_b16 v[234:235], v26 offset:25600
v_mfma_f32_16x16x32_bf16 v[88:91], v[244:247], v[104:107], v[88:91]
ds_read_b64_tr_b16 v[236:237], v27 offset:24576
v_mfma_f32_16x16x32_bf16 v[92:95], v[244:247], v[108:111], v[92:95]
ds_read_b64_tr_b16 v[238:239], v27 offset:25600
s_waitcnt lgkmcnt(8)
v_mfma_f32_16x16x32_bf16 v[160:163], v[216:219], v[104:107], v[160:163]
ds_read_b64_tr_b16 v[240:241], v28 offset:24576
v_mfma_f32_16x16x32_bf16 v[164:167], v[216:219], v[108:111], v[164:167]
ds_read_b64_tr_b16 v[242:243], v28 offset:25600
v_mfma_f32_16x16x32_bf16 v[168:171], v[220:223], v[104:107], v[168:171]
ds_read_b64_tr_b16 v[244:245], v29 offset:24576
v_mfma_f32_16x16x32_bf16 v[172:175], v[220:223], v[108:111], v[172:175]
ds_read_b64_tr_b16 v[246:247], v29 offset:25600
s_waitcnt lgkmcnt(8)
v_mfma_f32_16x16x32_bf16 v[176:179], v[224:227], v[104:107], v[176:179]
s_barrier
ds_read_b64_tr_b16 v[216:217], v22 offset:32768
v_mfma_f32_16x16x32_bf16 v[180:183], v[224:227], v[108:111], v[180:183]
ds_read_b64_tr_b16 v[218:219], v22 offset:33792
ds_read_b128 v[96:99], v30 offset:49152
v_mfma_f32_16x16x32_bf16 v[184:187], v[228:231], v[104:107], v[184:187]
ds_read_b64_tr_b16 v[220:221], v23 offset:32768
v_mfma_f32_16x16x32_bf16 v[188:191], v[228:231], v[108:111], v[188:191]
ds_read_b64_tr_b16 v[222:223], v23 offset:33792
ds_read_b128 v[100:103], v30 offset:51200
s_waitcnt lgkmcnt(10)
v_mfma_f32_16x16x32_bf16 v[192:195], v[232:235], v[104:107], v[192:195]
ds_read_b64_tr_b16 v[224:225], v24 offset:32768
v_mfma_f32_16x16x32_bf16 v[196:199], v[232:235], v[108:111], v[196:199]
ds_read_b64_tr_b16 v[226:227], v24 offset:33792
v_mfma_f32_16x16x32_bf16 v[200:203], v[236:239], v[104:107], v[200:203]
ds_read_b64_tr_b16 v[228:229], v25 offset:32768
v_mfma_f32_16x16x32_bf16 v[204:207], v[236:239], v[108:111], v[204:207]
ds_read_b64_tr_b16 v[230:231], v25 offset:33792
s_waitcnt lgkmcnt(10)
v_mfma_f32_16x16x32_bf16 v[208:211], v[240:243], v[104:107], v[208:211]
ds_read_b64_tr_b16 v[232:233], v26 offset:32768
v_mfma_f32_16x16x32_bf16 v[212:215], v[240:243], v[108:111], v[212:215]
ds_read_b64_tr_b16 v[234:235], v26 offset:33792
v_mfma_f32_16x16x32_bf16 v[248:251], v[244:247], v[104:107], v[248:251]
ds_read_b64_tr_b16 v[236:237], v27 offset:32768
v_mfma_f32_16x16x32_bf16 v[252:255], v[244:247], v[108:111], v[252:255]
ds_read_b64_tr_b16 v[238:239], v27 offset:33792
s_waitcnt lgkmcnt(8)
v_mfma_f32_16x16x32_bf16 v[32:35], v[216:219], v[96:99], v[32:35]
ds_read_b64_tr_b16 v[240:241], v28 offset:32768
v_mfma_f32_16x16x32_bf16 v[36:39], v[216:219], v[100:103], v[36:39]
ds_read_b64_tr_b16 v[242:243], v28 offset:33792
v_mfma_f32_16x16x32_bf16 v[40:43], v[220:223], v[96:99], v[40:43]
ds_read_b64_tr_b16 v[244:245], v29 offset:32768
v_mfma_f32_16x16x32_bf16 v[44:47], v[220:223], v[100:103], v[44:47]
ds_read_b64_tr_b16 v[246:247], v29 offset:33792
s_waitcnt lgkmcnt(8)
v_mfma_f32_16x16x32_bf16 v[48:51], v[224:227], v[96:99], v[48:51]
ds_read_b64_tr_b16 v[216:217], v22 offset:40960
v_mfma_f32_16x16x32_bf16 v[52:55], v[224:227], v[100:103], v[52:55]
ds_read_b64_tr_b16 v[218:219], v22 offset:41984
v_mfma_f32_16x16x32_bf16 v[56:59], v[228:231], v[96:99], v[56:59]
ds_read_b64_tr_b16 v[220:221], v23 offset:40960
v_mfma_f32_16x16x32_bf16 v[60:63], v[228:231], v[100:103], v[60:63]
ds_read_b64_tr_b16 v[222:223], v23 offset:41984
s_waitcnt lgkmcnt(8)
v_mfma_f32_16x16x32_bf16 v[64:67], v[232:235], v[96:99], v[64:67]
ds_read_b64_tr_b16 v[224:225], v24 offset:40960
v_mfma_f32_16x16x32_bf16 v[68:71], v[232:235], v[100:103], v[68:71]
ds_read_b64_tr_b16 v[226:227], v24 offset:41984
v_mfma_f32_16x16x32_bf16 v[72:75], v[236:239], v[96:99], v[72:75]
ds_read_b64_tr_b16 v[228:229], v25 offset:40960
v_mfma_f32_16x16x32_bf16 v[76:79], v[236:239], v[100:103], v[76:79]
ds_read_b64_tr_b16 v[230:231], v25 offset:41984
s_waitcnt lgkmcnt(8)
v_mfma_f32_16x16x32_bf16 v[80:83], v[240:243], v[96:99], v[80:83]
ds_read_b64_tr_b16 v[232:233], v26 offset:40960
v_mfma_f32_16x16x32_bf16 v[84:87], v[240:243], v[100:103], v[84:87]
ds_read_b64_tr_b16 v[234:235], v26 offset:41984
v_mfma_f32_16x16x32_bf16 v[88:91], v[244:247], v[96:99], v[88:91]
ds_read_b64_tr_b16 v[236:237], v27 offset:40960
v_mfma_f32_16x16x32_bf16 v[92:95], v[244:247], v[100:103], v[92:95]
ds_read_b64_tr_b16 v[238:239], v27 offset:41984
s_waitcnt lgkmcnt(8)
v_mfma_f32_16x16x32_bf16 v[160:163], v[216:219], v[96:99], v[160:163]
ds_read_b64_tr_b16 v[240:241], v28 offset:40960
v_mfma_f32_16x16x32_bf16 v[164:167], v[216:219], v[100:103], v[164:167]
ds_read_b64_tr_b16 v[242:243], v28 offset:41984
v_mfma_f32_16x16x32_bf16 v[168:171], v[220:223], v[96:99], v[168:171]
ds_read_b64_tr_b16 v[244:245], v29 offset:40960
v_mfma_f32_16x16x32_bf16 v[172:175], v[220:223], v[100:103], v[172:175]
ds_read_b64_tr_b16 v[246:247], v29 offset:41984
s_waitcnt lgkmcnt(8)
v_mfma_f32_16x16x32_bf16 v[176:179], v[224:227], v[96:99], v[176:179]
s_barrier
ds_read_b64_tr_b16 v[216:217], v22 offset:49152
v_mfma_f32_16x16x32_bf16 v[180:183], v[224:227], v[100:103], v[180:183]
ds_read_b64_tr_b16 v[218:219], v22 offset:50176
ds_read_b128 v[104:107], v31 offset:49152
v_mfma_f32_16x16x32_bf16 v[184:187], v[228:231], v[96:99], v[184:187]
ds_read_b64_tr_b16 v[220:221], v23 offset:49152
v_mfma_f32_16x16x32_bf16 v[188:191], v[228:231], v[100:103], v[188:191]
ds_read_b64_tr_b16 v[222:223], v23 offset:50176
ds_read_b128 v[108:111], v31 offset:51200
s_waitcnt lgkmcnt(10)
v_mfma_f32_16x16x32_bf16 v[192:195], v[232:235], v[96:99], v[192:195]
ds_read_b64_tr_b16 v[224:225], v24 offset:49152
v_mfma_f32_16x16x32_bf16 v[196:199], v[232:235], v[100:103], v[196:199]
ds_read_b64_tr_b16 v[226:227], v24 offset:50176
v_mfma_f32_16x16x32_bf16 v[200:203], v[236:239], v[96:99], v[200:203]
ds_read_b64_tr_b16 v[228:229], v25 offset:49152
v_mfma_f32_16x16x32_bf16 v[204:207], v[236:239], v[100:103], v[204:207]
ds_read_b64_tr_b16 v[230:231], v25 offset:50176
s_waitcnt lgkmcnt(10)
v_mfma_f32_16x16x32_bf16 v[208:211], v[240:243], v[96:99], v[208:211]
ds_read_b64_tr_b16 v[232:233], v26 offset:49152
v_mfma_f32_16x16x32_bf16 v[212:215], v[240:243], v[100:103], v[212:215]
ds_read_b64_tr_b16 v[234:235], v26 offset:50176
v_mfma_f32_16x16x32_bf16 v[248:251], v[244:247], v[96:99], v[248:251]
ds_read_b64_tr_b16 v[236:237], v27 offset:49152
v_mfma_f32_16x16x32_bf16 v[252:255], v[244:247], v[100:103], v[252:255]
ds_read_b64_tr_b16 v[238:239], v27 offset:50176
s_waitcnt lgkmcnt(8)
v_mfma_f32_16x16x32_bf16 v[32:35], v[216:219], v[104:107], v[32:35]
ds_read_b64_tr_b16 v[240:241], v28 offset:49152
v_mfma_f32_16x16x32_bf16 v[36:39], v[216:219], v[108:111], v[36:39]
ds_read_b64_tr_b16 v[242:243], v28 offset:50176
v_mfma_f32_16x16x32_bf16 v[40:43], v[220:223], v[104:107], v[40:43]
ds_read_b64_tr_b16 v[244:245], v29 offset:49152
v_mfma_f32_16x16x32_bf16 v[44:47], v[220:223], v[108:111], v[44:47]
ds_read_b64_tr_b16 v[246:247], v29 offset:50176
s_waitcnt lgkmcnt(8)
v_mfma_f32_16x16x32_bf16 v[48:51], v[224:227], v[104:107], v[48:51]
ds_read_b64_tr_b16 v[216:217], v22 offset:57344
v_mfma_f32_16x16x32_bf16 v[52:55], v[224:227], v[108:111], v[52:55]
ds_read_b64_tr_b16 v[218:219], v22 offset:58368
v_mfma_f32_16x16x32_bf16 v[56:59], v[228:231], v[104:107], v[56:59]
ds_read_b64_tr_b16 v[220:221], v23 offset:57344
v_mfma_f32_16x16x32_bf16 v[60:63], v[228:231], v[108:111], v[60:63]
ds_read_b64_tr_b16 v[222:223], v23 offset:58368
s_waitcnt lgkmcnt(8)
v_mfma_f32_16x16x32_bf16 v[64:67], v[232:235], v[104:107], v[64:67]
ds_read_b64_tr_b16 v[224:225], v24 offset:57344
v_mfma_f32_16x16x32_bf16 v[68:71], v[232:235], v[108:111], v[68:71]
ds_read_b64_tr_b16 v[226:227], v24 offset:58368
v_mfma_f32_16x16x32_bf16 v[72:75], v[236:239], v[104:107], v[72:75]
ds_read_b64_tr_b16 v[228:229], v25 offset:57344
v_mfma_f32_16x16x32_bf16 v[76:79], v[236:239], v[108:111], v[76:79]
ds_read_b64_tr_b16 v[230:231], v25 offset:58368
s_waitcnt lgkmcnt(8)
v_mfma_f32_16x16x32_bf16 v[80:83], v[240:243], v[104:107], v[80:83]
ds_read_b64_tr_b16 v[232:233], v26 offset:57344
v_mfma_f32_16x16x32_bf16 v[84:87], v[240:243], v[108:111], v[84:87]
ds_read_b64_tr_b16 v[234:235], v26 offset:58368
v_mfma_f32_16x16x32_bf16 v[88:91], v[244:247], v[104:107], v[88:91]
ds_read_b64_tr_b16 v[236:237], v27 offset:57344
v_mfma_f32_16x16x32_bf16 v[92:95], v[244:247], v[108:111], v[92:95]
ds_read_b64_tr_b16 v[238:239], v27 offset:58368
s_waitcnt lgkmcnt(8)
v_mfma_f32_16x16x32_bf16 v[160:163], v[216:219], v[104:107], v[160:163]
ds_read_b64_tr_b16 v[240:241], v28 offset:57344
v_mfma_f32_16x16x32_bf16 v[164:167], v[216:219], v[108:111], v[164:167]
ds_read_b64_tr_b16 v[242:243], v28 offset:58368
v_mfma_f32_16x16x32_bf16 v[168:171], v[220:223], v[104:107], v[168:171]
ds_read_b64_tr_b16 v[244:245], v29 offset:57344
v_mfma_f32_16x16x32_bf16 v[172:175], v[220:223], v[108:111], v[172:175]
ds_read_b64_tr_b16 v[246:247], v29 offset:58368
s_waitcnt lgkmcnt(8)
v_mfma_f32_16x16x32_bf16 v[176:179], v[224:227], v[104:107], v[176:179]
s_barrier
ds_read_b64_tr_b16 v[216:217], v22 offset:0
v_mfma_f32_16x16x32_bf16 v[180:183], v[224:227], v[108:111], v[180:183]
ds_read_b64_tr_b16 v[218:219], v22 offset:1024
ds_read_b128 v[96:99], v30 offset:0
v_mfma_f32_16x16x32_bf16 v[184:187], v[228:231], v[104:107], v[184:187]
ds_read_b64_tr_b16 v[220:221], v23 offset:0
v_mfma_f32_16x16x32_bf16 v[188:191], v[228:231], v[108:111], v[188:191]
ds_read_b64_tr_b16 v[222:223], v23 offset:1024
ds_read_b128 v[100:103], v30 offset:2048
s_waitcnt lgkmcnt(10)
v_mfma_f32_16x16x32_bf16 v[192:195], v[232:235], v[104:107], v[192:195]
ds_read_b64_tr_b16 v[224:225], v24 offset:0
v_mfma_f32_16x16x32_bf16 v[196:199], v[232:235], v[108:111], v[196:199]
ds_read_b64_tr_b16 v[226:227], v24 offset:1024
v_mfma_f32_16x16x32_bf16 v[200:203], v[236:239], v[104:107], v[200:203]
ds_read_b64_tr_b16 v[228:229], v25 offset:0
v_mfma_f32_16x16x32_bf16 v[204:207], v[236:239], v[108:111], v[204:207]
ds_read_b64_tr_b16 v[230:231], v25 offset:1024
s_waitcnt lgkmcnt(10)
v_mfma_f32_16x16x32_bf16 v[208:211], v[240:243], v[104:107], v[208:211]
ds_read_b64_tr_b16 v[232:233], v26 offset:0
v_mfma_f32_16x16x32_bf16 v[212:215], v[240:243], v[108:111], v[212:215]
ds_read_b64_tr_b16 v[234:235], v26 offset:1024
v_mfma_f32_16x16x32_bf16 v[248:251], v[244:247], v[104:107], v[248:251]
ds_read_b64_tr_b16 v[236:237], v27 offset:0
v_mfma_f32_16x16x32_bf16 v[252:255], v[244:247], v[108:111], v[252:255]
ds_read_b64_tr_b16 v[238:239], v27 offset:1024
s_add_u32 s71, s71, 1
s_cmp_lt_u32 s71, 4
s_cbranch_scc1 c1_qj_loop
s_mov_b32 s77, 1040356334
s_waitcnt lgkmcnt(0)
v_mul_f32 v32, s77, v32
v_mul_f32 v33, s77, v33
v_mul_f32 v34, s77, v34
v_mul_f32 v35, s77, v35
v_cvt_pk_bf16_f32 v96, v32, v33
v_cvt_pk_bf16_f32 v97, v34, v35
v_mul_f32 v36, s77, v36
v_mul_f32 v37, s77, v37
v_mul_f32 v38, s77, v38
v_mul_f32 v39, s77, v39
v_cvt_pk_bf16_f32 v98, v36, v37
v_cvt_pk_bf16_f32 v99, v38, v39
v_mul_f32 v40, s77, v40
v_mul_f32 v41, s77, v41
v_mul_f32 v42, s77, v42
v_mul_f32 v43, s77, v43
v_cvt_pk_bf16_f32 v100, v40, v41
v_cvt_pk_bf16_f32 v101, v42, v43
v_mul_f32 v44, s77, v44
v_mul_f32 v45, s77, v45
v_mul_f32 v46, s77, v46
v_mul_f32 v47, s77, v47
v_cvt_pk_bf16_f32 v102, v44, v45
v_cvt_pk_bf16_f32 v103, v46, v47
v_permlane16_swap_b32 v96, v98
v_permlane16_swap_b32 v97, v99
v_mul_f32 v48, s77, v48
v_mul_f32 v49, s77, v49
v_mul_f32 v50, s77, v50
v_mul_f32 v51, s77, v51
v_cvt_pk_bf16_f32 v104, v48, v49
v_cvt_pk_bf16_f32 v105, v50, v51
v_mul_f32 v52, s77, v52
v_mul_f32 v53, s77, v53
v_mul_f32 v54, s77, v54
v_mul_f32 v55, s77, v55
v_cvt_pk_bf16_f32 v106, v52, v53
v_cvt_pk_bf16_f32 v107, v54, v55
v_permlane16_swap_b32 v100, v102
v_permlane16_swap_b32 v101, v103
v_mul_f32 v56, s77, v56
v_mul_f32 v57, s77, v57
v_mul_f32 v58, s77, v58
v_mul_f32 v59, s77, v59
v_cvt_pk_bf16_f32 v108, v56, v57
v_cvt_pk_bf16_f32 v109, v58, v59
v_mul_f32 v60, s77, v60
v_mul_f32 v61, s77, v61
v_mul_f32 v62, s77, v62
v_mul_f32 v63, s77, v63
v_cvt_pk_bf16_f32 v110, v60, v61
v_cvt_pk_bf16_f32 v111, v62, v63
v_permlane16_swap_b32 v104, v106
v_permlane16_swap_b32 v105, v107
v_mul_f32 v64, s77, v64
v_mul_f32 v65, s77, v65
v_mul_f32 v66, s77, v66
v_mul_f32 v67, s77, v67
v_cvt_pk_bf16_f32 v112, v64, v65
v_cvt_pk_bf16_f32 v113, v66, v67
v_mul_f32 v68, s77, v68
v_mul_f32 v69, s77, v69
v_mul_f32 v70, s77, v70
v_mul_f32 v71, s77, v71
v_cvt_pk_bf16_f32 v114, v68, v69
v_cvt_pk_bf16_f32 v115, v70, v71
v_permlane16_swap_b32 v108, v110
v_permlane16_swap_b32 v109, v111
v_mul_f32 v72, s77, v72
v_mul_f32 v73, s77, v73
v_mul_f32 v74, s77, v74
v_mul_f32 v75, s77, v75
v_cvt_pk_bf16_f32 v116, v72, v73
v_cvt_pk_bf16_f32 v117, v74, v75
v_mul_f32 v76, s77, v76
v_mul_f32 v77, s77, v77
v_mul_f32 v78, s77, v78
v_mul_f32 v79, s77, v79
v_cvt_pk_bf16_f32 v118, v76, v77
v_cvt_pk_bf16_f32 v119, v78, v79
v_permlane16_swap_b32 v112, v114
v_permlane16_swap_b32 v113, v115
v_mul_f32 v80, s77, v80
v_mul_f32 v81, s77, v81
v_mul_f32 v82, s77, v82
v_mul_f32 v83, s77, v83
v_cvt_pk_bf16_f32 v120, v80, v81
v_cvt_pk_bf16_f32 v121, v82, v83
v_mul_f32 v84, s77, v84
v_mul_f32 v85, s77, v85
v_mul_f32 v86, s77, v86
v_mul_f32 v87, s77, v87
v_cvt_pk_bf16_f32 v122, v84, v85
v_cvt_pk_bf16_f32 v123, v86, v87
v_permlane16_swap_b32 v116, v118
v_permlane16_swap_b32 v117, v119
v_mul_f32 v88, s77, v88
v_mul_f32 v89, s77, v89
v_mul_f32 v90, s77, v90
v_mul_f32 v91, s77, v91
v_cvt_pk_bf16_f32 v124, v88, v89
v_cvt_pk_bf16_f32 v125, v90, v91
v_mul_f32 v92, s77, v92
v_mul_f32 v93, s77, v93
v_mul_f32 v94, s77, v94
v_mul_f32 v95, s77, v95
v_cvt_pk_bf16_f32 v126, v92, v93
v_cvt_pk_bf16_f32 v127, v94, v95
v_permlane16_swap_b32 v120, v122
v_permlane16_swap_b32 v121, v123
v_mul_f32 v160, s77, v160
v_mul_f32 v161, s77, v161
v_mul_f32 v162, s77, v162
v_mul_f32 v163, s77, v163
v_cvt_pk_bf16_f32 v128, v160, v161
v_cvt_pk_bf16_f32 v129, v162, v163
v_mul_f32 v164, s77, v164
v_mul_f32 v165, s77, v165
v_mul_f32 v166, s77, v166
v_mul_f32 v167, s77, v167
v_cvt_pk_bf16_f32 v130, v164, v165
v_cvt_pk_bf16_f32 v131, v166, v167
v_permlane16_swap_b32 v124, v126
v_permlane16_swap_b32 v125, v127
v_mul_f32 v168, s77, v168
v_mul_f32 v169, s77, v169
v_mul_f32 v170, s77, v170
v_mul_f32 v171, s77, v171
v_cvt_pk_bf16_f32 v132, v168, v169
v_cvt_pk_bf16_f32 v133, v170, v171
v_mul_f32 v172, s77, v172
v_mul_f32 v173, s77, v173
v_mul_f32 v174, s77, v174
v_mul_f32 v175, s77, v175
v_cvt_pk_bf16_f32 v134, v172, v173
v_cvt_pk_bf16_f32 v135, v174, v175
v_permlane16_swap_b32 v128, v130
v_permlane16_swap_b32 v129, v131
v_mul_f32 v176, s77, v176
v_mul_f32 v177, s77, v177
v_mul_f32 v178, s77, v178
v_mul_f32 v179, s77, v179
v_cvt_pk_bf16_f32 v136, v176, v177
v_cvt_pk_bf16_f32 v137, v178, v179
v_mul_f32 v180, s77, v180
v_mul_f32 v181, s77, v181
v_mul_f32 v182, s77, v182
v_mul_f32 v183, s77, v183
v_cvt_pk_bf16_f32 v138, v180, v181
v_cvt_pk_bf16_f32 v139, v182, v183
v_permlane16_swap_b32 v132, v134
v_permlane16_swap_b32 v133, v135
v_mul_f32 v184, s77, v184
v_mul_f32 v185, s77, v185
v_mul_f32 v186, s77, v186
v_mul_f32 v187, s77, v187
v_cvt_pk_bf16_f32 v140, v184, v185
v_cvt_pk_bf16_f32 v141, v186, v187
v_mul_f32 v188, s77, v188
v_mul_f32 v189, s77, v189
v_mul_f32 v190, s77, v190
v_mul_f32 v191, s77, v191
v_cvt_pk_bf16_f32 v142, v188, v189
v_cvt_pk_bf16_f32 v143, v190, v191
v_permlane16_swap_b32 v136, v138
v_permlane16_swap_b32 v137, v139
v_mul_f32 v192, s77, v192
v_mul_f32 v193, s77, v193
v_mul_f32 v194, s77, v194
v_mul_f32 v195, s77, v195
v_cvt_pk_bf16_f32 v144, v192, v193
v_cvt_pk_bf16_f32 v145, v194, v195
v_mul_f32 v196, s77, v196
v_mul_f32 v197, s77, v197
v_mul_f32 v198, s77, v198
v_mul_f32 v199, s77, v199
v_cvt_pk_bf16_f32 v146, v196, v197
v_cvt_pk_bf16_f32 v147, v198, v199
v_permlane16_swap_b32 v140, v142
v_permlane16_swap_b32 v141, v143
v_mul_f32 v200, s77, v200
v_mul_f32 v201, s77, v201
v_mul_f32 v202, s77, v202
v_mul_f32 v203, s77, v203
v_cvt_pk_bf16_f32 v148, v200, v201
v_cvt_pk_bf16_f32 v149, v202, v203
v_mul_f32 v204, s77, v204
v_mul_f32 v205, s77, v205
v_mul_f32 v206, s77, v206
v_mul_f32 v207, s77, v207
v_cvt_pk_bf16_f32 v150, v204, v205
v_cvt_pk_bf16_f32 v151, v206, v207
v_permlane16_swap_b32 v144, v146
v_permlane16_swap_b32 v145, v147
v_mul_f32 v208, s77, v208
v_mul_f32 v209, s77, v209
v_mul_f32 v210, s77, v210
v_mul_f32 v211, s77, v211
v_cvt_pk_bf16_f32 v152, v208, v209
v_cvt_pk_bf16_f32 v153, v210, v211
v_mul_f32 v212, s77, v212
v_mul_f32 v213, s77, v213
v_mul_f32 v214, s77, v214
v_mul_f32 v215, s77, v215
v_cvt_pk_bf16_f32 v154, v212, v213
v_cvt_pk_bf16_f32 v155, v214, v215
v_permlane16_swap_b32 v148, v150
v_permlane16_swap_b32 v149, v151
v_mul_f32 v248, s77, v248
v_mul_f32 v249, s77, v249
v_mul_f32 v250, s77, v250
v_mul_f32 v251, s77, v251
v_cvt_pk_bf16_f32 v156, v248, v249
v_cvt_pk_bf16_f32 v157, v250, v251
v_mul_f32 v252, s77, v252
v_mul_f32 v253, s77, v253
v_mul_f32 v254, s77, v254
v_mul_f32 v255, s77, v255
v_cvt_pk_bf16_f32 v158, v252, v253
v_cvt_pk_bf16_f32 v159, v254, v255
v_permlane16_swap_b32 v152, v154
v_permlane16_swap_b32 v153, v155
s_nop 1
v_permlane16_swap_b32 v156, v158
v_permlane16_swap_b32 v157, v159
s_branch c1_next
c1_a:
s_cmp_eq_u32 s79, 0
s_cbranch_scc1 c1_a0
v_mov_b32 v96, v128
v_mov_b32 v97, v129
v_mov_b32 v98, v130
v_mov_b32 v99, v131
v_mov_b32 v100, v132
v_mov_b32 v101, v133
v_mov_b32 v102, v134
v_mov_b32 v103, v135
v_mov_b32 v104, v136
v_mov_b32 v105, v137
v_mov_b32 v106, v138
v_mov_b32 v107, v139
v_mov_b32 v108, v140
v_mov_b32 v109, v141
v_mov_b32 v110, v142
v_mov_b32 v111, v143
v_mov_b32 v112, v144
v_mov_b32 v113, v145
v_mov_b32 v114, v146
v_mov_b32 v115, v147
v_mov_b32 v116, v148
v_mov_b32 v117, v149
v_mov_b32 v118, v150
v_mov_b32 v119, v151
v_mov_b32 v120, v152
v_mov_b32 v121, v153
v_mov_b32 v122, v154
v_mov_b32 v123, v155
v_mov_b32 v124, v156
v_mov_b32 v125, v157
v_mov_b32 v126, v158
v_mov_b32 v127, v159
c1_a0:
v_add_u32 v192, 0x20000, v10
v_add_u32 v193, 0x20000, v11
v_add_u32 v194, 0x20000, v12
v_add_u32 v195, 0x20000, v13
v_add_u32 v196, 0x20000, v14
v_add_u32 v197, 0x20000, v15
v_add_u32 v198, 0x20000, v16
v_add_u32 v199, 0x20000, v17
ds_read_b128 v[216:219], v192
ds_read_b128 v[220:223], v193
ds_read_b128 v[224:227], v194
ds_read_b128 v[228:231], v195
ds_read_b128 v[232:235], v196
ds_read_b128 v[236:239], v197
ds_read_b128 v[240:243], v198
ds_read_b128 v[244:247], v199
v_mov_b32 v2, 0
v_mov_b32 v3, 0
s_mov_b32 s71, 0
s_mov_b32 s78, 1090519040
s_waitcnt lgkmcnt(7)
v_mfma_f32_32x32x16_bf16 v[176:191], v[216:219], v[96:99], 0
v_mov_b32 v32, 0
v_mov_b32 v33, 0
v_mov_b32 v34, 0
v_mov_b32 v35, 0
v_mov_b32 v36, 0
v_mov_b32 v37, 0
v_mov_b32 v38, 0
v_mov_b32 v39, 0
s_waitcnt lgkmcnt(6)
v_mfma_f32_32x32x16_bf16 v[176:191], v[220:223], v[100:103], v[176:191]
v_mov_b32 v40, 0
v_mov_b32 v41, 0
v_mov_b32 v42, 0
v_mov_b32 v43, 0
v_mov_b32 v44, 0
v_mov_b32 v45, 0
v_mov_b32 v46, 0
v_mov_b32 v47, 0
s_waitcnt lgkmcnt(5)
v_mfma_f32_32x32x16_bf16 v[176:191], v[224:227], v[104:107], v[176:191]
v_mov_b32 v48, 0
v_mov_b32 v49, 0
v_mov_b32 v50, 0
v_mov_b32 v51, 0
v_mov_b32 v52, 0
v_mov_b32 v53, 0
v_mov_b32 v54, 0
v_mov_b32 v55, 0
s_waitcnt lgkmcnt(4)
v_mfma_f32_32x32x16_bf16 v[176:191], v[228:231], v[108:111], v[176:191]
v_mov_b32 v56, 0
v_mov_b32 v57, 0
v_mov_b32 v58, 0
v_mov_b32 v59, 0
v_mov_b32 v60, 0
v_mov_b32 v61, 0
v_mov_b32 v62, 0
v_mov_b32 v63, 0
s_waitcnt lgkmcnt(3)
v_mfma_f32_32x32x16_bf16 v[176:191], v[232:235], v[112:115], v[176:191]
v_mov_b32 v64, 0
v_mov_b32 v65, 0
v_mov_b32 v66, 0
v_mov_b32 v67, 0
v_mov_b32 v68, 0
v_mov_b32 v69, 0
v_mov_b32 v70, 0
v_mov_b32 v71, 0
s_waitcnt lgkmcnt(2)
v_mfma_f32_32x32x16_bf16 v[176:191], v[236:239], v[116:119], v[176:191]
v_mov_b32 v72, 0
v_mov_b32 v73, 0
v_mov_b32 v74, 0
v_mov_b32 v75, 0
v_mov_b32 v76, 0
v_mov_b32 v77, 0
v_mov_b32 v78, 0
v_mov_b32 v79, 0
s_waitcnt lgkmcnt(1)
v_mfma_f32_32x32x16_bf16 v[176:191], v[240:243], v[120:123], v[176:191]
v_mov_b32 v80, 0
v_mov_b32 v81, 0
v_mov_b32 v82, 0
v_mov_b32 v83, 0
v_mov_b32 v84, 0
v_mov_b32 v85, 0
v_mov_b32 v86, 0
v_mov_b32 v87, 0
s_waitcnt lgkmcnt(0)
v_mfma_f32_32x32x16_bf16 v[176:191], v[244:247], v[124:127], v[176:191]
v_mov_b32 v88, 0
v_mov_b32 v89, 0
v_mov_b32 v90, 0
v_mov_b32 v91, 0
v_mov_b32 v92, 0
v_mov_b32 v93, 0
v_mov_b32 v94, 0
v_mov_b32 v95, 0
ds_read_b128 v[216:219], v10 offset:0
ds_read_b128 v[220:223], v11 offset:0
ds_read_b128 v[224:227], v12 offset:0
ds_read_b128 v[228:231], v13 offset:0
ds_read_b128 v[232:235], v14 offset:0
s_nop 0
v_max3_f32 v4, v176, v177, v178
v_max3_f32 v5, v179, v180, v181
v_max3_f32 v4, v182, v183, v4
v_max3_f32 v5, v184, v185, v5
v_max3_f32 v4, v186, v187, v4
v_max3_f32 v5, v188, v189, v5
v_max3_f32 v4, v190, v191, v4
v_max_f32 v4, v4, v5
v_mov_b32 v5, v4
s_nop 1
v_permlane32_swap_b32 v4, v5
v_max_f32 v4, v4, v5
v_sub_f32 v176, v176, v4
v_sub_f32 v177, v177, v4
v_sub_f32 v178, v178, v4
v_sub_f32 v179, v179, v4
v_sub_f32 v180, v180, v4
v_sub_f32 v181, v181, v4
v_sub_f32 v182, v182, v4
v_sub_f32 v183, v183, v4
v_sub_f32 v184, v184, v4
v_sub_f32 v185, v185, v4
v_sub_f32 v186, v186, v4
v_sub_f32 v187, v187, v4
v_sub_f32 v188, v188, v4
v_sub_f32 v189, v189, v4
v_sub_f32 v190, v190, v4
v_sub_f32 v191, v191, v4
v_xor_b32 v160, 0x80000000, v4
v_xor_b32 v161, 0x80000000, v4
v_xor_b32 v162, 0x80000000, v4
v_xor_b32 v163, 0x80000000, v4
v_xor_b32 v164, 0x80000000, v4
v_xor_b32 v165, 0x80000000, v4
v_xor_b32 v166, 0x80000000, v4
v_xor_b32 v167, 0x80000000, v4
v_xor_b32 v168, 0x80000000, v4
v_xor_b32 v169, 0x80000000, v4
v_xor_b32 v170, 0x80000000, v4
v_xor_b32 v171, 0x80000000, v4
v_xor_b32 v172, 0x80000000, v4
v_xor_b32 v173, 0x80000000, v4
v_xor_b32 v174, 0x80000000, v4
v_xor_b32 v175, 0x80000000, v4
s_nop 0
c1_a_loop:
s_waitcnt lgkmcnt(3)
v_mfma_f32_32x32x16_bf16 v[192:207], v[216:219], v[96:99], v[160:175]
ds_read_b128 v[236:239], v15 offset:0
v_exp_f32 v176, v176
v_exp_f32 v177, v177
v_add_f32 v2, v2, v176
v_mfma_f32_32x32x16_bf16 v[192:207], v[220:223], v[100:103], v[192:207]
ds_read_b128 v[240:243], v16 offset:0
v_exp_f32 v178, v178
v_exp_f32 v179, v179
s_waitcnt lgkmcnt(3)
v_mfma_f32_32x32x16_bf16 v[192:207], v[224:227], v[104:107], v[192:207]
ds_read_b128 v[244:247], v17 offset:0
v_exp_f32 v180, v180
v_exp_f32 v181, v181
v_cvt_pk_bf16_f32 v208, v176, v177
v_mfma_f32_32x32x16_bf16 v[192:207], v[228:231], v[108:111], v[192:207]
ds_read_b64_tr_b16 v[216:217], v18 offset:0
ds_read_b64_tr_b16 v[218:219], v18 offset:2048
v_exp_f32 v182, v182
v_cvt_pk_bf16_f32 v209, v178, v179
s_waitcnt lgkmcnt(4)
v_mfma_f32_32x32x16_bf16 v[192:207], v[232:235], v[112:115], v[192:207]
ds_read_b64_tr_b16 v[220:221], v19 offset:0
ds_read_b64_tr_b16 v[222:223], v19 offset:2048
v_exp_f32 v183, v183
v_cvt_pk_bf16_f32 v210, v180, v181
v_add_f32 v3, v3, v177
v_mfma_f32_32x32x16_bf16 v[192:207], v[236:239], v[116:119], v[192:207]
ds_read_b64_tr_b16 v[224:225], v20 offset:0
ds_read_b64_tr_b16 v[226:227], v20 offset:2048
v_exp_f32 v184, v184
v_cvt_pk_bf16_f32 v211, v182, v183
s_waitcnt lgkmcnt(6)
v_mfma_f32_32x32x16_bf16 v[192:207], v[240:243], v[120:123], v[192:207]
ds_read_b64_tr_b16 v[228:229], v21 offset:0
ds_read_b64_tr_b16 v[230:231], v21 offset:2048
v_exp_f32 v185, v185
v_exp_f32 v186, v186
v_mfma_f32_32x32x16_bf16 v[192:207], v[244:247], v[124:127], v[192:207]
ds_read_b64_tr_b16 v[232:233], v18 offset:4096
ds_read_b64_tr_b16 v[234:235], v18 offset:6144
v_exp_f32 v187, v187
v_add_f32 v2, v2, v178
s_waitcnt lgkmcnt(6)
v_mfma_f32_32x32x16_bf16 v[32:47], v[216:219], v[208:211], v[32:47]
ds_read_b64_tr_b16 v[236:237], v19 offset:4096
ds_read_b64_tr_b16 v[238:239], v19 offset:6144
v_exp_f32 v188, v188
v_exp_f32 v189, v189
v_mfma_f32_32x32x16_bf16 v[48:63], v[220:223], v[208:211], v[48:63]
ds_read_b64_tr_b16 v[240:241], v20 offset:4096
ds_read_b64_tr_b16 v[242:243], v20 offset:6144
v_exp_f32 v190, v190
v_cvt_pk_bf16_f32 v212, v184, v185
s_waitcnt lgkmcnt(6)
v_mfma_f32_32x32x16_bf16 v[64:79], v[224:227], v[208:211], v[64:79]
ds_read_b64_tr_b16 v[244:245], v21 offset:4096
ds_read_b64_tr_b16 v[246:247], v21 offset:6144
v_exp_f32 v191, v191
v_cvt_pk_bf16_f32 v213, v186, v187
v_cvt_pk_bf16_f32 v214, v188, v189
v_mfma_f32_32x32x16_bf16 v[80:95], v[228:231], v[208:211], v[80:95]
ds_read_b128 v[216:219], v10 offset:8192
v_cvt_pk_bf16_f32 v215, v190, v191
v_max3_f32 v4, v192, v193, v194
v_max3_f32 v5, v195, v196, v197
v_add_f32 v3, v3, v179
s_waitcnt lgkmcnt(5)
v_mfma_f32_32x32x16_bf16 v[32:47], v[232:235], v[212:215], v[32:47]
ds_read_b128 v[220:223], v11 offset:8192
v_max3_f32 v4, v198, v199, v4
v_max3_f32 v5, v200, v201, v5
v_add_f32 v2, v2, v180
v_add_f32 v3, v3, v181
v_add_f32 v2, v2, v182
v_mfma_f32_32x32x16_bf16 v[48:63], v[236:239], v[212:215], v[48:63]
ds_read_b128 v[224:227], v12 offset:8192
v_max3_f32 v4, v202, v203, v4
v_max3_f32 v5, v204, v205, v5
v_add_f32 v3, v3, v183
v_add_f32 v2, v2, v184
s_waitcnt lgkmcnt(3)
v_mfma_f32_32x32x16_bf16 v[64:79], v[240:243], v[212:215], v[64:79]
ds_read_b128 v[228:231], v13 offset:8192
v_max3_f32 v4, v206, v207, v4
v_add_f32 v3, v3, v185
v_max_f32 v4, v4, v5
v_add_f32 v2, v2, v186
v_add_f32 v3, v3, v187
v_mfma_f32_32x32x16_bf16 v[80:95], v[244:247], v[212:215], v[80:95]
ds_read_b128 v[232:235], v14 offset:8192
v_cmp_lt_f32 vcc, s78, v4
v_add_f32 v2, v2, v188
v_add_f32 v3, v3, v189
v_add_f32 v2, v2, v190
v_add_f32 v3, v3, v191
s_cbranch_vccnz c1_rs22
c1_rb22:
s_waitcnt lgkmcnt(3)
v_mfma_f32_32x32x16_bf16 v[176:191], v[216:219], v[96:99], v[160:175]
ds_read_b128 v[236:239], v15 offset:8192
v_exp_f32 v192, v192
v_exp_f32 v193, v193
v_add_f32 v2, v2, v192
v_mfma_f32_32x32x16_bf16 v[176:191], v[220:223], v[100:103], v[176:191]
ds_read_b128 v[240:243], v16 offset:8192
v_exp_f32 v194, v194
v_exp_f32 v195, v195
s_waitcnt lgkmcnt(3)
v_mfma_f32_32x32x16_bf16 v[176:191], v[224:227], v[104:107], v[176:191]
ds_read_b128 v[244:247], v17 offset:8192
v_exp_f32 v196, v196
v_exp_f32 v197, v197
v_cvt_pk_bf16_f32 v208, v192, v193
v_mfma_f32_32x32x16_bf16 v[176:191], v[228:231], v[108:111], v[176:191]
ds_read_b64_tr_b16 v[216:217], v18 offset:8192
ds_read_b64_tr_b16 v[218:219], v18 offset:10240
v_exp_f32 v198, v198
v_cvt_pk_bf16_f32 v209, v194, v195
s_waitcnt lgkmcnt(4)
v_mfma_f32_32x32x16_bf16 v[176:191], v[232:235], v[112:115], v[176:191]
ds_read_b64_tr_b16 v[220:221], v19 offset:8192
ds_read_b64_tr_b16 v[222:223], v19 offset:10240
v_exp_f32 v199, v199
v_cvt_pk_bf16_f32 v210, v196, v197
v_add_f32 v3, v3, v193
v_mfma_f32_32x32x16_bf16 v[176:191], v[236:239], v[116:119], v[176:191]
ds_read_b64_tr_b16 v[224:225], v20 offset:8192
ds_read_b64_tr_b16 v[226:227], v20 offset:10240
v_exp_f32 v200, v200
v_cvt_pk_bf16_f32 v211, v198, v199
s_waitcnt lgkmcnt(6)
v_mfma_f32_32x32x16_bf16 v[176:191], v[240:243], v[120:123], v[176:191]
ds_read_b64_tr_b16 v[228:229], v21 offset:8192
ds_read_b64_tr_b16 v[230:231], v21 offset:10240
v_exp_f32 v201, v201
v_exp_f32 v202, v202
v_mfma_f32_32x32x16_bf16 v[176:191], v[244:247], v[124:127], v[176:191]
ds_read_b64_tr_b16 v[232:233], v18 offset:12288
ds_read_b64_tr_b16 v[234:235], v18 offset:14336
v_exp_f32 v203, v203
v_add_f32 v2, v2, v194
s_waitcnt lgkmcnt(6)
v_mfma_f32_32x32x16_bf16 v[32:47], v[216:219], v[208:211], v[32:47]
ds_read_b64_tr_b16 v[236:237], v19 offset:12288
ds_read_b64_tr_b16 v[238:239], v19 offset:14336
v_exp_f32 v204, v204
v_exp_f32 v205, v205
v_mfma_f32_32x32x16_bf16 v[48:63], v[220:223], v[208:211], v[48:63]
ds_read_b64_tr_b16 v[240:241], v20 offset:12288
ds_read_b64_tr_b16 v[242:243], v20 offset:14336
v_exp_f32 v206, v206
v_cvt_pk_bf16_f32 v212, v200, v201
s_waitcnt lgkmcnt(6)
v_mfma_f32_32x32x16_bf16 v[64:79], v[224:227], v[208:211], v[64:79]
ds_read_b64_tr_b16 v[244:245], v21 offset:12288
ds_read_b64_tr_b16 v[246:247], v21 offset:14336
v_exp_f32 v207, v207
v_cvt_pk_bf16_f32 v213, v202, v203
v_cvt_pk_bf16_f32 v214, v204, v205
v_mfma_f32_32x32x16_bf16 v[80:95], v[228:231], v[208:211], v[80:95]
s_barrier
ds_read_b128 v[216:219], v10 offset:16384
v_cvt_pk_bf16_f32 v215, v206, v207
v_max3_f32 v4, v176, v177, v178
v_max3_f32 v5, v179, v180, v181
v_add_f32 v3, v3, v195
s_waitcnt lgkmcnt(5)
v_mfma_f32_32x32x16_bf16 v[32:47], v[232:235], v[212:215], v[32:47]
ds_read_b128 v[220:223], v11 offset:16384
v_max3_f32 v4, v182, v183, v4
v_max3_f32 v5, v184, v185, v5
v_add_f32 v2, v2, v196
v_add_f32 v3, v3, v197
v_add_f32 v2, v2, v198
v_mfma_f32_32x32x16_bf16 v[48:63], v[236:239], v[212:215], v[48:63]
ds_read_b128 v[224:227], v12 offset:16384
v_max3_f32 v4, v186, v187, v4
v_max3_f32 v5, v188, v189, v5
v_add_f32 v3, v3, v199
v_add_f32 v2, v2, v200
s_waitcnt lgkmcnt(3)
v_mfma_f32_32x32x16_bf16 v[64:79], v[240:243], v[212:215], v[64:79]
ds_read_b128 v[228:231], v13 offset:16384
v_max3_f32 v4, v190, v191, v4
v_add_f32 v3, v3, v201
v_max_f32 v4, v4, v5
v_add_f32 v2, v2, v202
v_add_f32 v3, v3, v203
v_mfma_f32_32x32x16_bf16 v[80:95], v[244:247], v[212:215], v[80:95]
ds_read_b128 v[232:235], v14 offset:16384
v_cmp_lt_f32 vcc, s78, v4
v_add_f32 v2, v2, v204
v_add_f32 v3, v3, v205
v_add_f32 v2, v2, v206
v_add_f32 v3, v3, v207
s_cbranch_vccnz c1_rs23
c1_rb23:
s_waitcnt lgkmcnt(3)
v_mfma_f32_32x32x16_bf16 v[192:207], v[216:219], v[96:99], v[160:175]
ds_read_b128 v[236:239], v15 offset:16384
v_exp_f32 v176, v176
v_exp_f32 v177, v177
v_add_f32 v2, v2, v176
v_mfma_f32_32x32x16_bf16 v[192:207], v[220:223], v[100:103], v[192:207]
ds_read_b128 v[240:243], v16 offset:16384
v_exp_f32 v178, v178
v_exp_f32 v179, v179
s_waitcnt lgkmcnt(3)
v_mfma_f32_32x32x16_bf16 v[192:207], v[224:227], v[104:107], v[192:207]
ds_read_b128 v[244:247], v17 offset:16384
v_exp_f32 v180, v180
v_exp_f32 v181, v181
v_cvt_pk_bf16_f32 v208, v176, v177
v_mfma_f32_32x32x16_bf16 v[192:207], v[228:231], v[108:111], v[192:207]
ds_read_b64_tr_b16 v[216:217], v18 offset:16384
ds_read_b64_tr_b16 v[218:219], v18 offset:18432
v_exp_f32 v182, v182
v_cvt_pk_bf16_f32 v209, v178, v179
s_waitcnt lgkmcnt(4)
v_mfma_f32_32x32x16_bf16 v[192:207], v[232:235], v[112:115], v[192:207]
ds_read_b64_tr_b16 v[220:221], v19 offset:16384
ds_read_b64_tr_b16 v[222:223], v19 offset:18432
v_exp_f32 v183, v183
v_cvt_pk_bf16_f32 v210, v180, v181
v_add_f32 v3, v3, v177
v_mfma_f32_32x32x16_bf16 v[192:207], v[236:239], v[116:119], v[192:207]
ds_read_b64_tr_b16 v[224:225], v20 offset:16384
ds_read_b64_tr_b16 v[226:227], v20 offset:18432
v_exp_f32 v184, v184
v_cvt_pk_bf16_f32 v211, v182, v183
s_waitcnt lgkmcnt(6)
v_mfma_f32_32x32x16_bf16 v[192:207], v[240:243], v[120:123], v[192:207]
ds_read_b64_tr_b16 v[228:229], v21 offset:16384
ds_read_b64_tr_b16 v[230:231], v21 offset:18432
v_exp_f32 v185, v185
v_exp_f32 v186, v186
v_mfma_f32_32x32x16_bf16 v[192:207], v[244:247], v[124:127], v[192:207]
ds_read_b64_tr_b16 v[232:233], v18 offset:20480
ds_read_b64_tr_b16 v[234:235], v18 offset:22528
v_exp_f32 v187, v187
v_add_f32 v2, v2, v178
s_waitcnt lgkmcnt(6)
v_mfma_f32_32x32x16_bf16 v[32:47], v[216:219], v[208:211], v[32:47]
ds_read_b64_tr_b16 v[236:237], v19 offset:20480
ds_read_b64_tr_b16 v[238:239], v19 offset:22528
v_exp_f32 v188, v188
v_exp_f32 v189, v189
v_mfma_f32_32x32x16_bf16 v[48:63], v[220:223], v[208:211], v[48:63]
ds_read_b64_tr_b16 v[240:241], v20 offset:20480
ds_read_b64_tr_b16 v[242:243], v20 offset:22528
v_exp_f32 v190, v190
v_cvt_pk_bf16_f32 v212, v184, v185
s_waitcnt lgkmcnt(6)
v_mfma_f32_32x32x16_bf16 v[64:79], v[224:227], v[208:211], v[64:79]
ds_read_b64_tr_b16 v[244:245], v21 offset:20480
ds_read_b64_tr_b16 v[246:247], v21 offset:22528
v_exp_f32 v191, v191
v_cvt_pk_bf16_f32 v213, v186, v187
v_cvt_pk_bf16_f32 v214, v188, v189
v_mfma_f32_32x32x16_bf16 v[80:95], v[228:231], v[208:211], v[80:95]
ds_read_b128 v[216:219], v10 offset:24576
v_cvt_pk_bf16_f32 v215, v190, v191
v_max3_f32 v4, v192, v193, v194
v_max3_f32 v5, v195, v196, v197
v_add_f32 v3, v3, v179
s_waitcnt lgkmcnt(5)
v_mfma_f32_32x32x16_bf16 v[32:47], v[232:235], v[212:215], v[32:47]
ds_read_b128 v[220:223], v11 offset:24576
v_max3_f32 v4, v198, v199, v4
v_max3_f32 v5, v200, v201, v5
v_add_f32 v2, v2, v180
v_add_f32 v3, v3, v181
v_add_f32 v2, v2, v182
v_mfma_f32_32x32x16_bf16 v[48:63], v[236:239], v[212:215], v[48:63]
ds_read_b128 v[224:227], v12 offset:24576
v_max3_f32 v4, v202, v203, v4
v_max3_f32 v5, v204, v205, v5
v_add_f32 v3, v3, v183
v_add_f32 v2, v2, v184
s_waitcnt lgkmcnt(3)
v_mfma_f32_32x32x16_bf16 v[64:79], v[240:243], v[212:215], v[64:79]
ds_read_b128 v[228:231], v13 offset:24576
v_max3_f32 v4, v206, v207, v4
v_add_f32 v3, v3, v185
v_max_f32 v4, v4, v5
v_add_f32 v2, v2, v186
v_add_f32 v3, v3, v187
v_mfma_f32_32x32x16_bf16 v[80:95], v[244:247], v[212:215], v[80:95]
ds_read_b128 v[232:235], v14 offset:24576
v_cmp_lt_f32 vcc, s78, v4
v_add_f32 v2, v2, v188
v_add_f32 v3, v3, v189
v_add_f32 v2, v2, v190
v_add_f32 v3, v3, v191
s_cbranch_vccnz c1_rs24
c1_rb24:
s_waitcnt lgkmcnt(3)
v_mfma_f32_32x32x16_bf16 v[176:191], v[216:219], v[96:99], v[160:175]
ds_read_b128 v[236:239], v15 offset:24576
v_exp_f32 v192, v192
v_exp_f32 v193, v193
v_add_f32 v2, v2, v192
v_mfma_f32_32x32x16_bf16 v[176:191], v[220:223], v[100:103], v[176:191]
ds_read_b128 v[240:243], v16 offset:24576
v_exp_f32 v194, v194
v_exp_f32 v195, v195
s_waitcnt lgkmcnt(3)
v_mfma_f32_32x32x16_bf16 v[176:191], v[224:227], v[104:107], v[176:191]
ds_read_b128 v[244:247], v17 offset:24576
v_exp_f32 v196, v196
v_exp_f32 v197, v197
v_cvt_pk_bf16_f32 v208, v192, v193
v_mfma_f32_32x32x16_bf16 v[176:191], v[228:231], v[108:111], v[176:191]
ds_read_b64_tr_b16 v[216:217], v18 offset:24576
ds_read_b64_tr_b16 v[218:219], v18 offset:26624
v_exp_f32 v198, v198
v_cvt_pk_bf16_f32 v209, v194, v195
s_waitcnt lgkmcnt(4)
v_mfma_f32_32x32x16_bf16 v[176:191], v[232:235], v[112:115], v[176:191]
ds_read_b64_tr_b16 v[220:221], v19 offset:24576
ds_read_b64_tr_b16 v[222:223], v19 offset:26624
v_exp_f32 v199, v199
v_cvt_pk_bf16_f32 v210, v196, v197
v_add_f32 v3, v3, v193
v_mfma_f32_32x32x16_bf16 v[176:191], v[236:239], v[116:119], v[176:191]
ds_read_b64_tr_b16 v[224:225], v20 offset:24576
ds_read_b64_tr_b16 v[226:227], v20 offset:26624
v_exp_f32 v200, v200
v_cvt_pk_bf16_f32 v211, v198, v199
s_waitcnt lgkmcnt(6)
v_mfma_f32_32x32x16_bf16 v[176:191], v[240:243], v[120:123], v[176:191]
ds_read_b64_tr_b16 v[228:229], v21 offset:24576
ds_read_b64_tr_b16 v[230:231], v21 offset:26624
v_exp_f32 v201, v201
v_exp_f32 v202, v202
v_mfma_f32_32x32x16_bf16 v[176:191], v[244:247], v[124:127], v[176:191]
ds_read_b64_tr_b16 v[232:233], v18 offset:28672
ds_read_b64_tr_b16 v[234:235], v18 offset:30720
v_exp_f32 v203, v203
v_add_f32 v2, v2, v194
s_waitcnt lgkmcnt(6)
v_mfma_f32_32x32x16_bf16 v[32:47], v[216:219], v[208:211], v[32:47]
ds_read_b64_tr_b16 v[236:237], v19 offset:28672
ds_read_b64_tr_b16 v[238:239], v19 offset:30720
v_exp_f32 v204, v204
v_exp_f32 v205, v205
v_mfma_f32_32x32x16_bf16 v[48:63], v[220:223], v[208:211], v[48:63]
ds_read_b64_tr_b16 v[240:241], v20 offset:28672
ds_read_b64_tr_b16 v[242:243], v20 offset:30720
v_exp_f32 v206, v206
v_cvt_pk_bf16_f32 v212, v200, v201
s_waitcnt lgkmcnt(6)
v_mfma_f32_32x32x16_bf16 v[64:79], v[224:227], v[208:211], v[64:79]
ds_read_b64_tr_b16 v[244:245], v21 offset:28672
ds_read_b64_tr_b16 v[246:247], v21 offset:30720
v_exp_f32 v207, v207
v_cvt_pk_bf16_f32 v213, v202, v203
v_cvt_pk_bf16_f32 v214, v204, v205
v_mfma_f32_32x32x16_bf16 v[80:95], v[228:231], v[208:211], v[80:95]
s_waitcnt vmcnt(0)
s_barrier
s_cmp_lg_u32 s62, 0
s_cbranch_scc1 sg25
sb25:
ds_read_b128 v[216:219], v10 offset:32768
v_cvt_pk_bf16_f32 v215, v206, v207
v_max3_f32 v4, v176, v177, v178
v_max3_f32 v5, v179, v180, v181
v_add_f32 v3, v3, v195
s_waitcnt lgkmcnt(5)
v_mfma_f32_32x32x16_bf16 v[32:47], v[232:235], v[212:215], v[32:47]
ds_read_b128 v[220:223], v11 offset:32768
v_max3_f32 v4, v182, v183, v4
v_max3_f32 v5, v184, v185, v5
v_add_f32 v2, v2, v196
v_add_f32 v3, v3, v197
v_add_f32 v2, v2, v198
v_mfma_f32_32x32x16_bf16 v[48:63], v[236:239], v[212:215], v[48:63]
ds_read_b128 v[224:227], v12 offset:32768
v_max3_f32 v4, v186, v187, v4
v_max3_f32 v5, v188, v189, v5
v_add_f32 v3, v3, v199
v_add_f32 v2, v2, v200
s_waitcnt lgkmcnt(3)
v_mfma_f32_32x32x16_bf16 v[64:79], v[240:243], v[212:215], v[64:79]
ds_read_b128 v[228:231], v13 offset:32768
v_max3_f32 v4, v190, v191, v4
v_add_f32 v3, v3, v201
v_max_f32 v4, v4, v5
v_add_f32 v2, v2, v202
v_add_f32 v3, v3, v203
v_mfma_f32_32x32x16_bf16 v[80:95], v[244:247], v[212:215], v[80:95]
ds_read_b128 v[232:235], v14 offset:32768
v_cmp_lt_f32 vcc, s78, v4
v_add_f32 v2, v2, v204
v_add_f32 v3, v3, v205
v_add_f32 v2, v2, v206
v_add_f32 v3, v3, v207
s_cbranch_vccnz c1_rs26
c1_rb26:
s_waitcnt lgkmcnt(3)
v_mfma_f32_32x32x16_bf16 v[192:207], v[216:219], v[96:99], v[160:175]
ds_read_b128 v[236:239], v15 offset:32768
v_exp_f32 v176, v176
v_exp_f32 v177, v177
v_add_f32 v2, v2, v176
v_mfma_f32_32x32x16_bf16 v[192:207], v[220:223], v[100:103], v[192:207]
ds_read_b128 v[240:243], v16 offset:32768
v_exp_f32 v178, v178
v_exp_f32 v179, v179
s_waitcnt lgkmcnt(3)
v_mfma_f32_32x32x16_bf16 v[192:207], v[224:227], v[104:107], v[192:207]
ds_read_b128 v[244:247], v17 offset:32768
v_exp_f32 v180, v180
v_exp_f32 v181, v181
v_cvt_pk_bf16_f32 v208, v176, v177
v_mfma_f32_32x32x16_bf16 v[192:207], v[228:231], v[108:111], v[192:207]
ds_read_b64_tr_b16 v[216:217], v18 offset:32768
ds_read_b64_tr_b16 v[218:219], v18 offset:34816
v_exp_f32 v182, v182
v_cvt_pk_bf16_f32 v209, v178, v179
s_waitcnt lgkmcnt(4)
v_mfma_f32_32x32x16_bf16 v[192:207], v[232:235], v[112:115], v[192:207]
ds_read_b64_tr_b16 v[220:221], v19 offset:32768
ds_read_b64_tr_b16 v[222:223], v19 offset:34816
v_exp_f32 v183, v183
v_cvt_pk_bf16_f32 v210, v180, v181
v_add_f32 v3, v3, v177
v_mfma_f32_32x32x16_bf16 v[192:207], v[236:239], v[116:119], v[192:207]
ds_read_b64_tr_b16 v[224:225], v20 offset:32768
ds_read_b64_tr_b16 v[226:227], v20 offset:34816
v_exp_f32 v184, v184
v_cvt_pk_bf16_f32 v211, v182, v183
s_waitcnt lgkmcnt(6)
v_mfma_f32_32x32x16_bf16 v[192:207], v[240:243], v[120:123], v[192:207]
ds_read_b64_tr_b16 v[228:229], v21 offset:32768
ds_read_b64_tr_b16 v[230:231], v21 offset:34816
v_exp_f32 v185, v185
v_exp_f32 v186, v186
v_mfma_f32_32x32x16_bf16 v[192:207], v[244:247], v[124:127], v[192:207]
ds_read_b64_tr_b16 v[232:233], v18 offset:36864
ds_read_b64_tr_b16 v[234:235], v18 offset:38912
v_exp_f32 v187, v187
v_add_f32 v2, v2, v178
s_waitcnt lgkmcnt(6)
v_mfma_f32_32x32x16_bf16 v[32:47], v[216:219], v[208:211], v[32:47]
ds_read_b64_tr_b16 v[236:237], v19 offset:36864
ds_read_b64_tr_b16 v[238:239], v19 offset:38912
v_exp_f32 v188, v188
v_exp_f32 v189, v189
v_mfma_f32_32x32x16_bf16 v[48:63], v[220:223], v[208:211], v[48:63]
ds_read_b64_tr_b16 v[240:241], v20 offset:36864
ds_read_b64_tr_b16 v[242:243], v20 offset:38912
v_exp_f32 v190, v190
v_cvt_pk_bf16_f32 v212, v184, v185
s_waitcnt lgkmcnt(6)
v_mfma_f32_32x32x16_bf16 v[64:79], v[224:227], v[208:211], v[64:79]
ds_read_b64_tr_b16 v[244:245], v21 offset:36864
ds_read_b64_tr_b16 v[246:247], v21 offset:38912
v_exp_f32 v191, v191
v_cvt_pk_bf16_f32 v213, v186, v187
v_cvt_pk_bf16_f32 v214, v188, v189
v_mfma_f32_32x32x16_bf16 v[80:95], v[228:231], v[208:211], v[80:95]
ds_read_b128 v[216:219], v10 offset:40960
v_cvt_pk_bf16_f32 v215, v190, v191
v_max3_f32 v4, v192, v193, v194
v_max3_f32 v5, v195, v196, v197
v_add_f32 v3, v3, v179
s_waitcnt lgkmcnt(5)
v_mfma_f32_32x32x16_bf16 v[32:47], v[232:235], v[212:215], v[32:47]
ds_read_b128 v[220:223], v11 offset:40960
v_max3_f32 v4, v198, v199, v4
v_max3_f32 v5, v200, v201, v5
v_add_f32 v2, v2, v180
v_add_f32 v3, v3, v181
v_add_f32 v2, v2, v182
v_mfma_f32_32x32x16_bf16 v[48:63], v[236:239], v[212:215], v[48:63]
ds_read_b128 v[224:227], v12 offset:40960
v_max3_f32 v4, v202, v203, v4
v_max3_f32 v5, v204, v205, v5
v_add_f32 v3, v3, v183
v_add_f32 v2, v2, v184
s_waitcnt lgkmcnt(3)
v_mfma_f32_32x32x16_bf16 v[64:79], v[240:243], v[212:215], v[64:79]
ds_read_b128 v[228:231], v13 offset:40960
v_max3_f32 v4, v206, v207, v4
v_add_f32 v3, v3, v185
v_max_f32 v4, v4, v5
v_add_f32 v2, v2, v186
v_add_f32 v3, v3, v187
v_mfma_f32_32x32x16_bf16 v[80:95], v[244:247], v[212:215], v[80:95]
ds_read_b128 v[232:235], v14 offset:40960
v_cmp_lt_f32 vcc, s78, v4
v_add_f32 v2, v2, v188
v_add_f32 v3, v3, v189
v_add_f32 v2, v2, v190
v_add_f32 v3, v3, v191
s_cbranch_vccnz c1_rs27
c1_rb27:
s_waitcnt lgkmcnt(3)
v_mfma_f32_32x32x16_bf16 v[176:191], v[216:219], v[96:99], v[160:175]
ds_read_b128 v[236:239], v15 offset:40960
v_exp_f32 v192, v192
v_exp_f32 v193, v193
v_add_f32 v2, v2, v192
v_mfma_f32_32x32x16_bf16 v[176:191], v[220:223], v[100:103], v[176:191]
ds_read_b128 v[240:243], v16 offset:40960
v_exp_f32 v194, v194
v_exp_f32 v195, v195
s_waitcnt lgkmcnt(3)
v_mfma_f32_32x32x16_bf16 v[176:191], v[224:227], v[104:107], v[176:191]
ds_read_b128 v[244:247], v17 offset:40960
v_exp_f32 v196, v196
v_exp_f32 v197, v197
v_cvt_pk_bf16_f32 v208, v192, v193
v_mfma_f32_32x32x16_bf16 v[176:191], v[228:231], v[108:111], v[176:191]
ds_read_b64_tr_b16 v[216:217], v18 offset:40960
ds_read_b64_tr_b16 v[218:219], v18 offset:43008
v_exp_f32 v198, v198
v_cvt_pk_bf16_f32 v209, v194, v195
s_waitcnt lgkmcnt(4)
v_mfma_f32_32x32x16_bf16 v[176:191], v[232:235], v[112:115], v[176:191]
ds_read_b64_tr_b16 v[220:221], v19 offset:40960
ds_read_b64_tr_b16 v[222:223], v19 offset:43008
v_exp_f32 v199, v199
v_cvt_pk_bf16_f32 v210, v196, v197
v_add_f32 v3, v3, v193
v_mfma_f32_32x32x16_bf16 v[176:191], v[236:239], v[116:119], v[176:191]
ds_read_b64_tr_b16 v[224:225], v20 offset:40960
ds_read_b64_tr_b16 v[226:227], v20 offset:43008
v_exp_f32 v200, v200
v_cvt_pk_bf16_f32 v211, v198, v199
s_waitcnt lgkmcnt(6)
v_mfma_f32_32x32x16_bf16 v[176:191], v[240:243], v[120:123], v[176:191]
ds_read_b64_tr_b16 v[228:229], v21 offset:40960
ds_read_b64_tr_b16 v[230:231], v21 offset:43008
v_exp_f32 v201, v201
v_exp_f32 v202, v202
v_mfma_f32_32x32x16_bf16 v[176:191], v[244:247], v[124:127], v[176:191]
ds_read_b64_tr_b16 v[232:233], v18 offset:45056
ds_read_b64_tr_b16 v[234:235], v18 offset:47104
v_exp_f32 v203, v203
v_add_f32 v2, v2, v194
s_waitcnt lgkmcnt(6)
v_mfma_f32_32x32x16_bf16 v[32:47], v[216:219], v[208:211], v[32:47]
ds_read_b64_tr_b16 v[236:237], v19 offset:45056
ds_read_b64_tr_b16 v[238:239], v19 offset:47104
v_exp_f32 v204, v204
v_exp_f32 v205, v205
v_mfma_f32_32x32x16_bf16 v[48:63], v[220:223], v[208:211], v[48:63]
ds_read_b64_tr_b16 v[240:241], v20 offset:45056
ds_read_b64_tr_b16 v[242:243], v20 offset:47104
v_exp_f32 v206, v206
v_cvt_pk_bf16_f32 v212, v200, v201
s_waitcnt lgkmcnt(6)
v_mfma_f32_32x32x16_bf16 v[64:79], v[224:227], v[208:211], v[64:79]
ds_read_b64_tr_b16 v[244:245], v21 offset:45056
ds_read_b64_tr_b16 v[246:247], v21 offset:47104
v_exp_f32 v207, v207
v_cvt_pk_bf16_f32 v213, v202, v203
v_cvt_pk_bf16_f32 v214, v204, v205
v_mfma_f32_32x32x16_bf16 v[80:95], v[228:231], v[208:211], v[80:95]
s_barrier
ds_read_b128 v[216:219], v10 offset:49152
v_cvt_pk_bf16_f32 v215, v206, v207
v_max3_f32 v4, v176, v177, v178
v_max3_f32 v5, v179, v180, v181
v_add_f32 v3, v3, v195
s_waitcnt lgkmcnt(5)
v_mfma_f32_32x32x16_bf16 v[32:47], v[232:235], v[212:215], v[32:47]
ds_read_b128 v[220:223], v11 offset:49152
v_max3_f32 v4, v182, v183, v4
v_max3_f32 v5, v184, v185, v5
v_add_f32 v2, v2, v196
v_add_f32 v3, v3, v197
v_add_f32 v2, v2, v198
v_mfma_f32_32x32x16_bf16 v[48:63], v[236:239], v[212:215], v[48:63]
ds_read_b128 v[224:227], v12 offset:49152
v_max3_f32 v4, v186, v187, v4
v_max3_f32 v5, v188, v189, v5
v_add_f32 v3, v3, v199
v_add_f32 v2, v2, v200
s_waitcnt lgkmcnt(3)
v_mfma_f32_32x32x16_bf16 v[64:79], v[240:243], v[212:215], v[64:79]
ds_read_b128 v[228:231], v13 offset:49152
v_max3_f32 v4, v190, v191, v4
v_add_f32 v3, v3, v201
v_max_f32 v4, v4, v5
v_add_f32 v2, v2, v202
v_add_f32 v3, v3, v203
v_mfma_f32_32x32x16_bf16 v[80:95], v[244:247], v[212:215], v[80:95]
ds_read_b128 v[232:235], v14 offset:49152
v_cmp_lt_f32 vcc, s78, v4
v_add_f32 v2, v2, v204
v_add_f32 v3, v3, v205
v_add_f32 v2, v2, v206
v_add_f32 v3, v3, v207
s_cbranch_vccnz c1_rs28
c1_rb28:
s_waitcnt lgkmcnt(3)
v_mfma_f32_32x32x16_bf16 v[192:207], v[216:219], v[96:99], v[160:175]
ds_read_b128 v[236:239], v15 offset:49152
v_exp_f32 v176, v176
v_exp_f32 v177, v177
v_add_f32 v2, v2, v176
v_mfma_f32_32x32x16_bf16 v[192:207], v[220:223], v[100:103], v[192:207]
ds_read_b128 v[240:243], v16 offset:49152
v_exp_f32 v178, v178
v_exp_f32 v179, v179
s_waitcnt lgkmcnt(3)
v_mfma_f32_32x32x16_bf16 v[192:207], v[224:227], v[104:107], v[192:207]
ds_read_b128 v[244:247], v17 offset:49152
v_exp_f32 v180, v180
v_exp_f32 v181, v181
v_cvt_pk_bf16_f32 v208, v176, v177
v_mfma_f32_32x32x16_bf16 v[192:207], v[228:231], v[108:111], v[192:207]
ds_read_b64_tr_b16 v[216:217], v18 offset:49152
ds_read_b64_tr_b16 v[218:219], v18 offset:51200
v_exp_f32 v182, v182
v_cvt_pk_bf16_f32 v209, v178, v179
s_waitcnt lgkmcnt(4)
v_mfma_f32_32x32x16_bf16 v[192:207], v[232:235], v[112:115], v[192:207]
ds_read_b64_tr_b16 v[220:221], v19 offset:49152
ds_read_b64_tr_b16 v[222:223], v19 offset:51200
v_exp_f32 v183, v183
v_cvt_pk_bf16_f32 v210, v180, v181
v_add_f32 v3, v3, v177
v_mfma_f32_32x32x16_bf16 v[192:207], v[236:239], v[116:119], v[192:207]
ds_read_b64_tr_b16 v[224:225], v20 offset:49152
ds_read_b64_tr_b16 v[226:227], v20 offset:51200
v_exp_f32 v184, v184
v_cvt_pk_bf16_f32 v211, v182, v183
s_waitcnt lgkmcnt(6)
v_mfma_f32_32x32x16_bf16 v[192:207], v[240:243], v[120:123], v[192:207]
ds_read_b64_tr_b16 v[228:229], v21 offset:49152
ds_read_b64_tr_b16 v[230:231], v21 offset:51200
v_exp_f32 v185, v185
v_exp_f32 v186, v186
v_mfma_f32_32x32x16_bf16 v[192:207], v[244:247], v[124:127], v[192:207]
ds_read_b64_tr_b16 v[232:233], v18 offset:53248
ds_read_b64_tr_b16 v[234:235], v18 offset:55296
v_exp_f32 v187, v187
v_add_f32 v2, v2, v178
s_waitcnt lgkmcnt(6)
v_mfma_f32_32x32x16_bf16 v[32:47], v[216:219], v[208:211], v[32:47]
ds_read_b64_tr_b16 v[236:237], v19 offset:53248
ds_read_b64_tr_b16 v[238:239], v19 offset:55296
v_exp_f32 v188, v188
v_exp_f32 v189, v189
v_mfma_f32_32x32x16_bf16 v[48:63], v[220:223], v[208:211], v[48:63]
ds_read_b64_tr_b16 v[240:241], v20 offset:53248
ds_read_b64_tr_b16 v[242:243], v20 offset:55296
v_exp_f32 v190, v190
v_cvt_pk_bf16_f32 v212, v184, v185
s_waitcnt lgkmcnt(6)
v_mfma_f32_32x32x16_bf16 v[64:79], v[224:227], v[208:211], v[64:79]
ds_read_b64_tr_b16 v[244:245], v21 offset:53248
ds_read_b64_tr_b16 v[246:247], v21 offset:55296
v_exp_f32 v191, v191
v_cvt_pk_bf16_f32 v213, v186, v187
v_cvt_pk_bf16_f32 v214, v188, v189
v_mfma_f32_32x32x16_bf16 v[80:95], v[228:231], v[208:211], v[80:95]
ds_read_b128 v[216:219], v10 offset:57344
v_cvt_pk_bf16_f32 v215, v190, v191
v_max3_f32 v4, v192, v193, v194
v_max3_f32 v5, v195, v196, v197
v_add_f32 v3, v3, v179
s_waitcnt lgkmcnt(5)
v_mfma_f32_32x32x16_bf16 v[32:47], v[232:235], v[212:215], v[32:47]
ds_read_b128 v[220:223], v11 offset:57344
v_max3_f32 v4, v198, v199, v4
v_max3_f32 v5, v200, v201, v5
v_add_f32 v2, v2, v180
v_add_f32 v3, v3, v181
v_add_f32 v2, v2, v182
v_mfma_f32_32x32x16_bf16 v[48:63], v[236:239], v[212:215], v[48:63]
ds_read_b128 v[224:227], v12 offset:57344
v_max3_f32 v4, v202, v203, v4
v_max3_f32 v5, v204, v205, v5
v_add_f32 v3, v3, v183
v_add_f32 v2, v2, v184
s_waitcnt lgkmcnt(3)
v_mfma_f32_32x32x16_bf16 v[64:79], v[240:243], v[212:215], v[64:79]
ds_read_b128 v[228:231], v13 offset:57344
v_max3_f32 v4, v206, v207, v4
v_add_f32 v3, v3, v185
v_max_f32 v4, v4, v5
v_add_f32 v2, v2, v186
v_add_f32 v3, v3, v187
v_mfma_f32_32x32x16_bf16 v[80:95], v[244:247], v[212:215], v[80:95]
ds_read_b128 v[232:235], v14 offset:57344
v_cmp_lt_f32 vcc, s78, v4
v_add_f32 v2, v2, v188
v_add_f32 v3, v3, v189
v_add_f32 v2, v2, v190
v_add_f32 v3, v3, v191
s_cbranch_vccnz c1_rs29
c1_rb29:
s_cmp_eq_u32 s71, 3
s_cbranch_scc1 c1_a_last
s_waitcnt lgkmcnt(3)
v_mfma_f32_32x32x16_bf16 v[176:191], v[216:219], v[96:99], v[160:175]
ds_read_b128 v[236:239], v15 offset:57344
v_exp_f32 v192, v192
v_exp_f32 v193, v193
v_add_f32 v2, v2, v192
v_mfma_f32_32x32x16_bf16 v[176:191], v[220:223], v[100:103], v[176:191]
ds_read_b128 v[240:243], v16 offset:57344
v_exp_f32 v194, v194
v_exp_f32 v195, v195
s_waitcnt lgkmcnt(3)
v_mfma_f32_32x32x16_bf16 v[176:191], v[224:227], v[104:107], v[176:191]
ds_read_b128 v[244:247], v17 offset:57344
v_exp_f32 v196, v196
v_exp_f32 v197, v197
v_cvt_pk_bf16_f32 v208, v192, v193
v_mfma_f32_32x32x16_bf16 v[176:191], v[228:231], v[108:111], v[176:191]
ds_read_b64_tr_b16 v[216:217], v18 offset:57344
ds_read_b64_tr_b16 v[218:219], v18 offset:59392
v_exp_f32 v198, v198
v_cvt_pk_bf16_f32 v209, v194, v195
s_waitcnt lgkmcnt(4)
v_mfma_f32_32x32x16_bf16 v[176:191], v[232:235], v[112:115], v[176:191]
ds_read_b64_tr_b16 v[220:221], v19 offset:57344
ds_read_b64_tr_b16 v[222:223], v19 offset:59392
v_exp_f32 v199, v199
v_cvt_pk_bf16_f32 v210, v196, v197
v_add_f32 v3, v3, v193
v_mfma_f32_32x32x16_bf16 v[176:191], v[236:239], v[116:119], v[176:191]
ds_read_b64_tr_b16 v[224:225], v20 offset:57344
ds_read_b64_tr_b16 v[226:227], v20 offset:59392
v_exp_f32 v200, v200
v_cvt_pk_bf16_f32 v211, v198, v199
s_waitcnt lgkmcnt(6)
v_mfma_f32_32x32x16_bf16 v[176:191], v[240:243], v[120:123], v[176:191]
ds_read_b64_tr_b16 v[228:229], v21 offset:57344
ds_read_b64_tr_b16 v[230:231], v21 offset:59392
v_exp_f32 v201, v201
v_exp_f32 v202, v202
v_mfma_f32_32x32x16_bf16 v[176:191], v[244:247], v[124:127], v[176:191]
ds_read_b64_tr_b16 v[232:233], v18 offset:61440
ds_read_b64_tr_b16 v[234:235], v18 offset:63488
v_exp_f32 v203, v203
v_add_f32 v2, v2, v194
s_waitcnt lgkmcnt(6)
v_mfma_f32_32x32x16_bf16 v[32:47], v[216:219], v[208:211], v[32:47]
ds_read_b64_tr_b16 v[236:237], v19 offset:61440
ds_read_b64_tr_b16 v[238:239], v19 offset:63488
v_exp_f32 v204, v204
v_exp_f32 v205, v205
v_mfma_f32_32x32x16_bf16 v[48:63], v[220:223], v[208:211], v[48:63]
ds_read_b64_tr_b16 v[240:241], v20 offset:61440
ds_read_b64_tr_b16 v[242:243], v20 offset:63488
v_exp_f32 v206, v206
v_cvt_pk_bf16_f32 v212, v200, v201
s_waitcnt lgkmcnt(6)
v_mfma_f32_32x32x16_bf16 v[64:79], v[224:227], v[208:211], v[64:79]
ds_read_b64_tr_b16 v[244:245], v21 offset:61440
ds_read_b64_tr_b16 v[246:247], v21 offset:63488
v_exp_f32 v207, v207
v_cvt_pk_bf16_f32 v213, v202, v203
v_cvt_pk_bf16_f32 v214, v204, v205
v_mfma_f32_32x32x16_bf16 v[80:95], v[228:231], v[208:211], v[80:95]
s_barrier
ds_read_b128 v[216:219], v10 offset:0
v_cvt_pk_bf16_f32 v215, v206, v207
v_max3_f32 v4, v176, v177, v178
v_max3_f32 v5, v179, v180, v181
v_add_f32 v3, v3, v195
s_waitcnt lgkmcnt(5)
v_mfma_f32_32x32x16_bf16 v[32:47], v[232:235], v[212:215], v[32:47]
ds_read_b128 v[220:223], v11 offset:0
v_max3_f32 v4, v182, v183, v4
v_max3_f32 v5, v184, v185, v5
v_add_f32 v2, v2, v196
v_add_f32 v3, v3, v197
v_add_f32 v2, v2, v198
v_mfma_f32_32x32x16_bf16 v[48:63], v[236:239], v[212:215], v[48:63]
ds_read_b128 v[224:227], v12 offset:0
v_max3_f32 v4, v186, v187, v4
v_max3_f32 v5, v188, v189, v5
v_add_f32 v3, v3, v199
v_add_f32 v2, v2, v200
s_waitcnt lgkmcnt(3)
v_mfma_f32_32x32x16_bf16 v[64:79], v[240:243], v[212:215], v[64:79]
ds_read_b128 v[228:231], v13 offset:0
v_max3_f32 v4, v190, v191, v4
v_add_f32 v3, v3, v201
v_max_f32 v4, v4, v5
v_add_f32 v2, v2, v202
v_add_f32 v3, v3, v203
v_mfma_f32_32x32x16_bf16 v[80:95], v[244:247], v[212:215], v[80:95]
ds_read_b128 v[232:235], v14 offset:0
v_cmp_lt_f32 vcc, s78, v4
v_add_f32 v2, v2, v204
v_add_f32 v3, v3, v205
v_add_f32 v2, v2, v206
v_add_f32 v3, v3, v207
s_cbranch_vccnz c1_rs30
c1_rb30:
s_add_u32 s71, s71, 1
s_branch c1_a_loop
c1_a_last:
s_waitcnt lgkmcnt(0)
ds_read_b64_tr_b16 v[216:217], v18 offset:57344
ds_read_b64_tr_b16 v[218:219], v18 offset:59392
ds_read_b64_tr_b16 v[220:221], v19 offset:57344
ds_read_b64_tr_b16 v[222:223], v19 offset:59392
ds_read_b64_tr_b16 v[224:225], v20 offset:57344
ds_read_b64_tr_b16 v[226:227], v20 offset:59392
ds_read_b64_tr_b16 v[228:229], v21 offset:57344
ds_read_b64_tr_b16 v[230:231], v21 offset:59392
ds_read_b64_tr_b16 v[232:233], v18 offset:61440
ds_read_b64_tr_b16 v[234:235], v18 offset:63488
v_exp_f32 v192, v192
v_exp_f32 v193, v193
v_exp_f32 v194, v194
v_exp_f32 v195, v195
v_exp_f32 v196, v196
v_exp_f32 v197, v197
v_exp_f32 v198, v198
v_exp_f32 v199, v199
v_cvt_pk_bf16_f32 v208, v192, v193
v_cvt_pk_bf16_f32 v209, v194, v195
v_cvt_pk_bf16_f32 v210, v196, v197
v_cvt_pk_bf16_f32 v211, v198, v199
v_add_f32 v2, v2, v192
v_add_f32 v3, v3, v193
s_waitcnt lgkmcnt(6)
v_mfma_f32_32x32x16_bf16 v[32:47], v[216:219], v[208:211], v[32:47]
ds_read_b64_tr_b16 v[236:237], v19 offset:61440
ds_read_b64_tr_b16 v[238:239], v19 offset:63488
v_exp_f32 v200, v200
v_exp_f32 v201, v201
v_add_f32 v2, v2, v194
v_mfma_f32_32x32x16_bf16 v[48:63], v[220:223], v[208:211], v[48:63]
ds_read_b64_tr_b16 v[240:241], v20 offset:61440
ds_read_b64_tr_b16 v[242:243], v20 offset:63488
v_exp_f32 v202, v202
v_exp_f32 v203, v203
v_add_f32 v3, v3, v195
v_cvt_pk_bf16_f32 v212, v200, v201
s_waitcnt lgkmcnt(6)
v_mfma_f32_32x32x16_bf16 v[64:79], v[224:227], v[208:211], v[64:79]
ds_read_b64_tr_b16 v[244:245], v21 offset:61440
ds_read_b64_tr_b16 v[246:247], v21 offset:63488
v_exp_f32 v204, v204
v_exp_f32 v205, v205
v_exp_f32 v206, v206
v_cvt_pk_bf16_f32 v213, v202, v203
v_mfma_f32_32x32x16_bf16 v[80:95], v[228:231], v[208:211], v[80:95]
s_barrier
v_exp_f32 v207, v207
v_cvt_pk_bf16_f32 v214, v204, v205
v_add_f32 v2, v2, v196
v_cvt_pk_bf16_f32 v215, v206, v207
v_add_f32 v3, v3, v197
v_add_f32 v2, v2, v198
s_waitcnt lgkmcnt(4)
v_mfma_f32_32x32x16_bf16 v[32:47], v[232:235], v[212:215], v[32:47]
v_add_f32 v3, v3, v199
v_add_f32 v2, v2, v200
v_add_f32 v3, v3, v201
v_add_f32 v2, v2, v202
v_add_f32 v3, v3, v203
v_mfma_f32_32x32x16_bf16 v[48:63], v[236:239], v[212:215], v[48:63]
v_add_f32 v2, v2, v204
v_add_f32 v3, v3, v205
v_add_f32 v2, v2, v206
v_add_f32 v3, v3, v207
s_waitcnt lgkmcnt(0)
v_mfma_f32_32x32x16_bf16 v[64:79], v[240:243], v[212:215], v[64:79]
v_mfma_f32_32x32x16_bf16 v[80:95], v[244:247], v[212:215], v[80:95]
s_lshl_b32 s72, s67, 3
s_add_u32 s72, s72, s66
s_lshl_b32 s77, s72, 1
s_add_u32 s77, s77, s70
s_bfe_u32 s78, s65, 0x10001
s_lshl_b32 s77, s77, 1
s_xor_b32 s78, s78, 0
s_add_u32 s77, s77, s78
s_lshl_b32 s77, s77, 2
s_or_b32 s77, s77, 0x10000
s_cmp_eq_u32 s64, 0
s_cselect_b32 s62, s77, 0
s_lshl_b32 s72, s72, 5
s_add_u32 s72, s72, s65
s_add_u32 s72, s72, s70
s_lshl_b32 s72, s72, 2
s_add_u32 s72, s72, s64
s_lshl_b32 s72, s72, 13
s_add_u32 s73, s72, 4096
v_add_f32 v2, v2, v3
v_mov_b32 v3, v2
s_nop 1
v_permlane32_swap_b32 v2, v3
v_add_f32 v2, v2, v3
v_rcp_f32 v2, v2
s_nop 0
v_mul_f32 v32, v32, v2
v_mul_f32 v33, v33, v2
v_mul_f32 v34, v34, v2
v_mul_f32 v35, v35, v2
v_mul_f32 v36, v36, v2
v_mul_f32 v37, v37, v2
v_mul_f32 v38, v38, v2
v_mul_f32 v39, v39, v2
v_cvt_pk_bf16_f32 v216, v32, v33
v_cvt_pk_bf16_f32 v217, v34, v35
v_cvt_pk_bf16_f32 v218, v36, v37
v_cvt_pk_bf16_f32 v219, v38, v39
buffer_store_dwordx4 v[216:219], v1, s[20:23], s72 offen offset:0 sc1
v_mul_f32 v40, v40, v2
v_mul_f32 v41, v41, v2
v_mul_f32 v42, v42, v2
v_mul_f32 v43, v43, v2
v_mul_f32 v44, v44, v2
v_mul_f32 v45, v45, v2
v_mul_f32 v46, v46, v2
v_mul_f32 v47, v47, v2
v_cvt_pk_bf16_f32 v220, v40, v41
v_cvt_pk_bf16_f32 v221, v42, v43
v_cvt_pk_bf16_f32 v222, v44, v45
v_cvt_pk_bf16_f32 v223, v46, v47
buffer_store_dwordx4 v[220:223], v1, s[20:23], s72 offen offset:1024 sc1
v_mul_f32 v48, v48, v2
v_mul_f32 v49, v49, v2
v_mul_f32 v50, v50, v2
v_mul_f32 v51, v51, v2
v_mul_f32 v52, v52, v2
v_mul_f32 v53, v53, v2
v_mul_f32 v54, v54, v2
v_mul_f32 v55, v55, v2
v_cvt_pk_bf16_f32 v224, v48, v49
v_cvt_pk_bf16_f32 v225, v50, v51
v_cvt_pk_bf16_f32 v226, v52, v53
v_cvt_pk_bf16_f32 v227, v54, v55
buffer_store_dwordx4 v[224:227], v1, s[20:23], s72 offen offset:2048 sc1
v_mul_f32 v56, v56, v2
v_mul_f32 v57, v57, v2
v_mul_f32 v58, v58, v2
v_mul_f32 v59, v59, v2
v_mul_f32 v60, v60, v2
v_mul_f32 v61, v61, v2
v_mul_f32 v62, v62, v2
v_mul_f32 v63, v63, v2
v_cvt_pk_bf16_f32 v228, v56, v57
v_cvt_pk_bf16_f32 v229, v58, v59
v_cvt_pk_bf16_f32 v230, v60, v61
v_cvt_pk_bf16_f32 v231, v62, v63
buffer_store_dwordx4 v[228:231], v1, s[20:23], s72 offen offset:3072 sc1
v_mul_f32 v64, v64, v2
v_mul_f32 v65, v65, v2
v_mul_f32 v66, v66, v2
v_mul_f32 v67, v67, v2
v_mul_f32 v68, v68, v2
v_mul_f32 v69, v69, v2
v_mul_f32 v70, v70, v2
v_mul_f32 v71, v71, v2
v_cvt_pk_bf16_f32 v232, v64, v65
v_cvt_pk_bf16_f32 v233, v66, v67
v_cvt_pk_bf16_f32 v234, v68, v69
v_cvt_pk_bf16_f32 v235, v70, v71
buffer_store_dwordx4 v[232:235], v1, s[20:23], s73 offen offset:0 sc1
v_mul_f32 v72, v72, v2
v_mul_f32 v73, v73, v2
v_mul_f32 v74, v74, v2
v_mul_f32 v75, v75, v2
v_mul_f32 v76, v76, v2
v_mul_f32 v77, v77, v2
v_mul_f32 v78, v78, v2
v_mul_f32 v79, v79, v2
v_cvt_pk_bf16_f32 v236, v72, v73
v_cvt_pk_bf16_f32 v237, v74, v75
v_cvt_pk_bf16_f32 v238, v76, v77
v_cvt_pk_bf16_f32 v239, v78, v79
buffer_store_dwordx4 v[236:239], v1, s[20:23], s73 offen offset:1024 sc1
v_mul_f32 v80, v80, v2
v_mul_f32 v81, v81, v2
v_mul_f32 v82, v82, v2
v_mul_f32 v83, v83, v2
v_mul_f32 v84, v84, v2
v_mul_f32 v85, v85, v2
v_mul_f32 v86, v86, v2
v_mul_f32 v87, v87, v2
v_cvt_pk_bf16_f32 v240, v80, v81
v_cvt_pk_bf16_f32 v241, v82, v83
v_cvt_pk_bf16_f32 v242, v84, v85
v_cvt_pk_bf16_f32 v243, v86, v87
buffer_store_dwordx4 v[240:243], v1, s[20:23], s73 offen offset:2048 sc1
v_mul_f32 v88, v88, v2
v_mul_f32 v89, v89, v2
v_mul_f32 v90, v90, v2
v_mul_f32 v91, v91, v2
v_mul_f32 v92, v92, v2
v_mul_f32 v93, v93, v2
v_mul_f32 v94, v94, v2
v_mul_f32 v95, v95, v2
v_cvt_pk_bf16_f32 v244, v88, v89
v_cvt_pk_bf16_f32 v245, v90, v91
v_cvt_pk_bf16_f32 v246, v92, v93
v_cvt_pk_bf16_f32 v247, v94, v95
buffer_store_dwordx4 v[244:247], v1, s[20:23], s73 offen offset:3072 sc1
s_branch c1_next
c1_end:
concat_heads__mha_block_cached__mha_block_cached__near_ridge_kernel_fin:
concat_heads__mha_block_cached__mha_block_cached__near_ridge_kernel_end:
s_endpgm
fw17:
s_mov_b32 s79, 0
fl17:
global_load_dwordx4 v[20:23], v17, s[56:57] sc1
s_add_u32 s79, s79, 1
s_waitcnt vmcnt(0)
v_readfirstlane_b32 s78, v20
s_and_b32 s78, s78, 0xff
s_cmp_ge_u32 s78, 8
s_cbranch_scc1 fb17
s_cmp_lt_u32 s79, 0x8000
s_cbranch_scc1 fl17
s_branch fb17
fw18:
s_mov_b32 s79, 0
fl18:
global_load_dwordx4 v[20:23], v17, s[56:57] sc1
s_add_u32 s79, s79, 1
s_waitcnt vmcnt(0)
v_readfirstlane_b32 s78, v21
s_and_b32 s78, s78, 0xff
s_cmp_ge_u32 s78, 8
s_cbranch_scc1 fb18
s_cmp_lt_u32 s79, 0x8000
s_cbranch_scc1 fl18
s_branch fb18
lp_fl:
global_load_dwordx4 v[20:23], v17, s[56:57] sc1
s_waitcnt vmcnt(7)
s_branch lp_fb
lp_t2:
s_mov_b32 s72, 384
buffer_load_dword v31, v30, s[24:27], s72 offen
s_waitcnt vmcnt(7)
s_branch lp_tb2
fw19:
s_mov_b32 s79, 0
fl19:
global_load_dwordx4 v[20:23], v17, s[56:57] sc1
s_add_u32 s79, s79, 1
s_waitcnt vmcnt(0)
v_readfirstlane_b32 s78, v22
s_and_b32 s78, s78, 0xff
s_cmp_ge_u32 s78, 8
s_cbranch_scc1 fb19
s_cmp_lt_u32 s79, 0x8000
s_cbranch_scc1 fl19
s_branch fb19
fw20:
s_mov_b32 s79, 0
fl20:
global_load_dwordx4 v[20:23], v17, s[56:57] sc1
s_add_u32 s79, s79, 1
s_waitcnt vmcnt(0)
v_readfirstlane_b32 s78, v23
s_and_b32 s78, s78, 0xff
s_cmp_ge_u32 s78, 8
s_cbranch_scc1 fb20
s_cmp_lt_u32 s79, 0x8000
s_cbranch_scc1 fl20
s_branch fb20
sg21:
s_mov_b64 exec, 1
s_and_b32 s62, s62, 0xff
v_mov_b32 v6, s62
v_mov_b32 v7, 1
global_atomic_add v6, v7, s[56:57] sc1
s_mov_b64 exec, -1
s_mov_b32 s62, 0
s_nop 3
s_branch sb21
c1_rs22:
v_mov_b32 v5, v4
s_nop 1
v_permlane32_swap_b32 v4, v5
v_max_f32 v4, v4, v5
v_max_f32 v4, 0, v4
v_exp_f32 v5, -v4
s_nop 7
v_sub_f32 v192, v192, v4
v_sub_f32 v193, v193, v4
v_sub_f32 v194, v194, v4
v_sub_f32 v195, v195, v4
v_sub_f32 v196, v196, v4
v_sub_f32 v197, v197, v4
v_sub_f32 v198, v198, v4
v_sub_f32 v199, v199, v4
v_sub_f32 v200, v200, v4
v_sub_f32 v201, v201, v4
v_sub_f32 v202, v202, v4
v_sub_f32 v203, v203, v4
v_sub_f32 v204, v204, v4
v_sub_f32 v205, v205, v4
v_sub_f32 v206, v206, v4
v_sub_f32 v207, v207, v4
v_sub_f32 v160, v160, v4
v_sub_f32 v161, v161, v4
v_sub_f32 v162, v162, v4
v_sub_f32 v163, v163, v4
v_sub_f32 v164, v164, v4
v_sub_f32 v165, v165, v4
v_sub_f32 v166, v166, v4
v_sub_f32 v167, v167, v4
v_sub_f32 v168, v168, v4
v_sub_f32 v169, v169, v4
v_sub_f32 v170, v170, v4
v_sub_f32 v171, v171, v4
v_sub_f32 v172, v172, v4
v_sub_f32 v173, v173, v4
v_sub_f32 v174, v174, v4
v_sub_f32 v175, v175, v4
v_mul_f32 v2, v2, v5
v_mul_f32 v3, v3, v5
v_mul_f32 v32, v32, v5
v_mul_f32 v33, v33, v5
v_mul_f32 v34, v34, v5
v_mul_f32 v35, v35, v5
v_mul_f32 v36, v36, v5
v_mul_f32 v37, v37, v5
v_mul_f32 v38, v38, v5
v_mul_f32 v39, v39, v5
v_mul_f32 v40, v40, v5
v_mul_f32 v41, v41, v5
v_mul_f32 v42, v42, v5
v_mul_f32 v43, v43, v5
v_mul_f32 v44, v44, v5
v_mul_f32 v45, v45, v5
v_mul_f32 v46, v46, v5
v_mul_f32 v47, v47, v5
v_mul_f32 v48, v48, v5
v_mul_f32 v49, v49, v5
v_mul_f32 v50, v50, v5
v_mul_f32 v51, v51, v5
v_mul_f32 v52, v52, v5
v_mul_f32 v53, v53, v5
v_mul_f32 v54, v54, v5
v_mul_f32 v55, v55, v5
v_mul_f32 v56, v56, v5
v_mul_f32 v57, v57, v5
v_mul_f32 v58, v58, v5
v_mul_f32 v59, v59, v5
v_mul_f32 v60, v60, v5
v_mul_f32 v61, v61, v5
v_mul_f32 v62, v62, v5
v_mul_f32 v63, v63, v5
v_mul_f32 v64, v64, v5
v_mul_f32 v65, v65, v5
v_mul_f32 v66, v66, v5
v_mul_f32 v67, v67, v5
v_mul_f32 v68, v68, v5
v_mul_f32 v69, v69, v5
v_mul_f32 v70, v70, v5
v_mul_f32 v71, v71, v5
v_mul_f32 v72, v72, v5
v_mul_f32 v73, v73, v5
v_mul_f32 v74, v74, v5
v_mul_f32 v75, v75, v5
v_mul_f32 v76, v76, v5
v_mul_f32 v77, v77, v5
v_mul_f32 v78, v78, v5
v_mul_f32 v79, v79, v5
v_mul_f32 v80, v80, v5
v_mul_f32 v81, v81, v5
v_mul_f32 v82, v82, v5
v_mul_f32 v83, v83, v5
v_mul_f32 v84, v84, v5
v_mul_f32 v85, v85, v5
v_mul_f32 v86, v86, v5
v_mul_f32 v87, v87, v5
v_mul_f32 v88, v88, v5
v_mul_f32 v89, v89, v5
v_mul_f32 v90, v90, v5
v_mul_f32 v91, v91, v5
v_mul_f32 v92, v92, v5
v_mul_f32 v93, v93, v5
v_mul_f32 v94, v94, v5
v_mul_f32 v95, v95, v5
s_nop 1
s_branch c1_rb22
c1_rs23:
v_mov_b32 v5, v4
s_nop 1
v_permlane32_swap_b32 v4, v5
v_max_f32 v4, v4, v5
v_max_f32 v4, 0, v4
v_exp_f32 v5, -v4
s_nop 7
v_sub_f32 v176, v176, v4
v_sub_f32 v177, v177, v4
v_sub_f32 v178, v178, v4
v_sub_f32 v179, v179, v4
v_sub_f32 v180, v180, v4
v_sub_f32 v181, v181, v4
v_sub_f32 v182, v182, v4
v_sub_f32 v183, v183, v4
v_sub_f32 v184, v184, v4
v_sub_f32 v185, v185, v4
v_sub_f32 v186, v186, v4
v_sub_f32 v187, v187, v4
v_sub_f32 v188, v188, v4
v_sub_f32 v189, v189, v4
v_sub_f32 v190, v190, v4
v_sub_f32 v191, v191, v4
v_sub_f32 v160, v160, v4
v_sub_f32 v161, v161, v4
v_sub_f32 v162, v162, v4
v_sub_f32 v163, v163, v4
v_sub_f32 v164, v164, v4
v_sub_f32 v165, v165, v4
v_sub_f32 v166, v166, v4
v_sub_f32 v167, v167, v4
v_sub_f32 v168, v168, v4
v_sub_f32 v169, v169, v4
v_sub_f32 v170, v170, v4
v_sub_f32 v171, v171, v4
v_sub_f32 v172, v172, v4
v_sub_f32 v173, v173, v4
v_sub_f32 v174, v174, v4
v_sub_f32 v175, v175, v4
v_mul_f32 v2, v2, v5
v_mul_f32 v3, v3, v5
v_mul_f32 v32, v32, v5
v_mul_f32 v33, v33, v5
v_mul_f32 v34, v34, v5
v_mul_f32 v35, v35, v5
v_mul_f32 v36, v36, v5
v_mul_f32 v37, v37, v5
v_mul_f32 v38, v38, v5
v_mul_f32 v39, v39, v5
v_mul_f32 v40, v40, v5
v_mul_f32 v41, v41, v5
v_mul_f32 v42, v42, v5
v_mul_f32 v43, v43, v5
v_mul_f32 v44, v44, v5
v_mul_f32 v45, v45, v5
v_mul_f32 v46, v46, v5
v_mul_f32 v47, v47, v5
v_mul_f32 v48, v48, v5
v_mul_f32 v49, v49, v5
v_mul_f32 v50, v50, v5
v_mul_f32 v51, v51, v5
v_mul_f32 v52, v52, v5
v_mul_f32 v53, v53, v5
v_mul_f32 v54, v54, v5
v_mul_f32 v55, v55, v5
v_mul_f32 v56, v56, v5
v_mul_f32 v57, v57, v5
v_mul_f32 v58, v58, v5
v_mul_f32 v59, v59, v5
v_mul_f32 v60, v60, v5
v_mul_f32 v61, v61, v5
v_mul_f32 v62, v62, v5
v_mul_f32 v63, v63, v5
v_mul_f32 v64, v64, v5
v_mul_f32 v65, v65, v5
v_mul_f32 v66, v66, v5
v_mul_f32 v67, v67, v5
v_mul_f32 v68, v68, v5
v_mul_f32 v69, v69, v5
v_mul_f32 v70, v70, v5
v_mul_f32 v71, v71, v5
v_mul_f32 v72, v72, v5
v_mul_f32 v73, v73, v5
v_mul_f32 v74, v74, v5
v_mul_f32 v75, v75, v5
v_mul_f32 v76, v76, v5
v_mul_f32 v77, v77, v5
v_mul_f32 v78, v78, v5
v_mul_f32 v79, v79, v5
v_mul_f32 v80, v80, v5
v_mul_f32 v81, v81, v5
v_mul_f32 v82, v82, v5
v_mul_f32 v83, v83, v5
v_mul_f32 v84, v84, v5
v_mul_f32 v85, v85, v5
v_mul_f32 v86, v86, v5
v_mul_f32 v87, v87, v5
v_mul_f32 v88, v88, v5
v_mul_f32 v89, v89, v5
v_mul_f32 v90, v90, v5
v_mul_f32 v91, v91, v5
v_mul_f32 v92, v92, v5
v_mul_f32 v93, v93, v5
v_mul_f32 v94, v94, v5
v_mul_f32 v95, v95, v5
s_nop 1
s_branch c1_rb23
c1_rs24:
v_mov_b32 v5, v4
s_nop 1
v_permlane32_swap_b32 v4, v5
v_max_f32 v4, v4, v5
v_max_f32 v4, 0, v4
v_exp_f32 v5, -v4
s_nop 7
v_sub_f32 v192, v192, v4
v_sub_f32 v193, v193, v4
v_sub_f32 v194, v194, v4
v_sub_f32 v195, v195, v4
v_sub_f32 v196, v196, v4
v_sub_f32 v197, v197, v4
v_sub_f32 v198, v198, v4
v_sub_f32 v199, v199, v4
v_sub_f32 v200, v200, v4
v_sub_f32 v201, v201, v4
v_sub_f32 v202, v202, v4
v_sub_f32 v203, v203, v4
v_sub_f32 v204, v204, v4
v_sub_f32 v205, v205, v4
v_sub_f32 v206, v206, v4
v_sub_f32 v207, v207, v4
v_sub_f32 v160, v160, v4
v_sub_f32 v161, v161, v4
v_sub_f32 v162, v162, v4
v_sub_f32 v163, v163, v4
v_sub_f32 v164, v164, v4
v_sub_f32 v165, v165, v4
v_sub_f32 v166, v166, v4
v_sub_f32 v167, v167, v4
v_sub_f32 v168, v168, v4
v_sub_f32 v169, v169, v4
v_sub_f32 v170, v170, v4
v_sub_f32 v171, v171, v4
v_sub_f32 v172, v172, v4
v_sub_f32 v173, v173, v4
v_sub_f32 v174, v174, v4
v_sub_f32 v175, v175, v4
v_mul_f32 v2, v2, v5
v_mul_f32 v3, v3, v5
v_mul_f32 v32, v32, v5
v_mul_f32 v33, v33, v5
v_mul_f32 v34, v34, v5
v_mul_f32 v35, v35, v5
v_mul_f32 v36, v36, v5
v_mul_f32 v37, v37, v5
v_mul_f32 v38, v38, v5
v_mul_f32 v39, v39, v5
v_mul_f32 v40, v40, v5
v_mul_f32 v41, v41, v5
v_mul_f32 v42, v42, v5
v_mul_f32 v43, v43, v5
v_mul_f32 v44, v44, v5
v_mul_f32 v45, v45, v5
v_mul_f32 v46, v46, v5
v_mul_f32 v47, v47, v5
v_mul_f32 v48, v48, v5
v_mul_f32 v49, v49, v5
v_mul_f32 v50, v50, v5
v_mul_f32 v51, v51, v5
v_mul_f32 v52, v52, v5
v_mul_f32 v53, v53, v5
v_mul_f32 v54, v54, v5
v_mul_f32 v55, v55, v5
v_mul_f32 v56, v56, v5
v_mul_f32 v57, v57, v5
v_mul_f32 v58, v58, v5
v_mul_f32 v59, v59, v5
v_mul_f32 v60, v60, v5
v_mul_f32 v61, v61, v5
v_mul_f32 v62, v62, v5
v_mul_f32 v63, v63, v5
v_mul_f32 v64, v64, v5
v_mul_f32 v65, v65, v5
v_mul_f32 v66, v66, v5
v_mul_f32 v67, v67, v5
v_mul_f32 v68, v68, v5
v_mul_f32 v69, v69, v5
v_mul_f32 v70, v70, v5
v_mul_f32 v71, v71, v5
v_mul_f32 v72, v72, v5
v_mul_f32 v73, v73, v5
v_mul_f32 v74, v74, v5
v_mul_f32 v75, v75, v5
v_mul_f32 v76, v76, v5
v_mul_f32 v77, v77, v5
v_mul_f32 v78, v78, v5
v_mul_f32 v79, v79, v5
v_mul_f32 v80, v80, v5
v_mul_f32 v81, v81, v5
v_mul_f32 v82, v82, v5
v_mul_f32 v83, v83, v5
v_mul_f32 v84, v84, v5
v_mul_f32 v85, v85, v5
v_mul_f32 v86, v86, v5
v_mul_f32 v87, v87, v5
v_mul_f32 v88, v88, v5
v_mul_f32 v89, v89, v5
v_mul_f32 v90, v90, v5
v_mul_f32 v91, v91, v5
v_mul_f32 v92, v92, v5
v_mul_f32 v93, v93, v5
v_mul_f32 v94, v94, v5
v_mul_f32 v95, v95, v5
s_nop 1
s_branch c1_rb24
sg25:
s_mov_b64 exec, 1
s_and_b32 s62, s62, 0xff
v_mov_b32 v6, s62
v_mov_b32 v7, 1
global_atomic_add v6, v7, s[56:57] sc1
s_mov_b64 exec, -1
s_mov_b32 s62, 0
s_nop 3
s_branch sb25
c1_rs26:
v_mov_b32 v5, v4
s_nop 1
v_permlane32_swap_b32 v4, v5
v_max_f32 v4, v4, v5
v_max_f32 v4, 0, v4
v_exp_f32 v5, -v4
s_nop 7
v_sub_f32 v176, v176, v4
v_sub_f32 v177, v177, v4
v_sub_f32 v178, v178, v4
v_sub_f32 v179, v179, v4
v_sub_f32 v180, v180, v4
v_sub_f32 v181, v181, v4
v_sub_f32 v182, v182, v4
v_sub_f32 v183, v183, v4
v_sub_f32 v184, v184, v4
v_sub_f32 v185, v185, v4
v_sub_f32 v186, v186, v4
v_sub_f32 v187, v187, v4
v_sub_f32 v188, v188, v4
v_sub_f32 v189, v189, v4
v_sub_f32 v190, v190, v4
v_sub_f32 v191, v191, v4
v_sub_f32 v160, v160, v4
v_sub_f32 v161, v161, v4
v_sub_f32 v162, v162, v4
v_sub_f32 v163, v163, v4
v_sub_f32 v164, v164, v4
v_sub_f32 v165, v165, v4
v_sub_f32 v166, v166, v4
v_sub_f32 v167, v167, v4
v_sub_f32 v168, v168, v4
v_sub_f32 v169, v169, v4
v_sub_f32 v170, v170, v4
v_sub_f32 v171, v171, v4
v_sub_f32 v172, v172, v4
v_sub_f32 v173, v173, v4
v_sub_f32 v174, v174, v4
v_sub_f32 v175, v175, v4
v_mul_f32 v2, v2, v5
v_mul_f32 v3, v3, v5
v_mul_f32 v32, v32, v5
v_mul_f32 v33, v33, v5
v_mul_f32 v34, v34, v5
v_mul_f32 v35, v35, v5
v_mul_f32 v36, v36, v5
v_mul_f32 v37, v37, v5
v_mul_f32 v38, v38, v5
v_mul_f32 v39, v39, v5
v_mul_f32 v40, v40, v5
v_mul_f32 v41, v41, v5
v_mul_f32 v42, v42, v5
v_mul_f32 v43, v43, v5
v_mul_f32 v44, v44, v5
v_mul_f32 v45, v45, v5
v_mul_f32 v46, v46, v5
v_mul_f32 v47, v47, v5
v_mul_f32 v48, v48, v5
v_mul_f32 v49, v49, v5
v_mul_f32 v50, v50, v5
v_mul_f32 v51, v51, v5
v_mul_f32 v52, v52, v5
v_mul_f32 v53, v53, v5
v_mul_f32 v54, v54, v5
v_mul_f32 v55, v55, v5
v_mul_f32 v56, v56, v5
v_mul_f32 v57, v57, v5
v_mul_f32 v58, v58, v5
v_mul_f32 v59, v59, v5
v_mul_f32 v60, v60, v5
v_mul_f32 v61, v61, v5
v_mul_f32 v62, v62, v5
v_mul_f32 v63, v63, v5
v_mul_f32 v64, v64, v5
v_mul_f32 v65, v65, v5
v_mul_f32 v66, v66, v5
v_mul_f32 v67, v67, v5
v_mul_f32 v68, v68, v5
v_mul_f32 v69, v69, v5
v_mul_f32 v70, v70, v5
v_mul_f32 v71, v71, v5
v_mul_f32 v72, v72, v5
v_mul_f32 v73, v73, v5
v_mul_f32 v74, v74, v5
v_mul_f32 v75, v75, v5
v_mul_f32 v76, v76, v5
v_mul_f32 v77, v77, v5
v_mul_f32 v78, v78, v5
v_mul_f32 v79, v79, v5
v_mul_f32 v80, v80, v5
v_mul_f32 v81, v81, v5
v_mul_f32 v82, v82, v5
v_mul_f32 v83, v83, v5
v_mul_f32 v84, v84, v5
v_mul_f32 v85, v85, v5
v_mul_f32 v86, v86, v5
v_mul_f32 v87, v87, v5
v_mul_f32 v88, v88, v5
v_mul_f32 v89, v89, v5
v_mul_f32 v90, v90, v5
v_mul_f32 v91, v91, v5
v_mul_f32 v92, v92, v5
v_mul_f32 v93, v93, v5
v_mul_f32 v94, v94, v5
v_mul_f32 v95, v95, v5
s_nop 1
s_branch c1_rb26
c1_rs27:
v_mov_b32 v5, v4
s_nop 1
v_permlane32_swap_b32 v4, v5
v_max_f32 v4, v4, v5
v_max_f32 v4, 0, v4
v_exp_f32 v5, -v4
s_nop 7
v_sub_f32 v192, v192, v4
v_sub_f32 v193, v193, v4
v_sub_f32 v194, v194, v4
v_sub_f32 v195, v195, v4
v_sub_f32 v196, v196, v4
v_sub_f32 v197, v197, v4
v_sub_f32 v198, v198, v4
v_sub_f32 v199, v199, v4
v_sub_f32 v200, v200, v4
v_sub_f32 v201, v201, v4
v_sub_f32 v202, v202, v4
v_sub_f32 v203, v203, v4
v_sub_f32 v204, v204, v4
v_sub_f32 v205, v205, v4
v_sub_f32 v206, v206, v4
v_sub_f32 v207, v207, v4
v_sub_f32 v160, v160, v4
v_sub_f32 v161, v161, v4
v_sub_f32 v162, v162, v4
v_sub_f32 v163, v163, v4
v_sub_f32 v164, v164, v4
v_sub_f32 v165, v165, v4
v_sub_f32 v166, v166, v4
v_sub_f32 v167, v167, v4
v_sub_f32 v168, v168, v4
v_sub_f32 v169, v169, v4
v_sub_f32 v170, v170, v4
v_sub_f32 v171, v171, v4
v_sub_f32 v172, v172, v4
v_sub_f32 v173, v173, v4
v_sub_f32 v174, v174, v4
v_sub_f32 v175, v175, v4
v_mul_f32 v2, v2, v5
v_mul_f32 v3, v3, v5
v_mul_f32 v32, v32, v5
v_mul_f32 v33, v33, v5
v_mul_f32 v34, v34, v5
v_mul_f32 v35, v35, v5
v_mul_f32 v36, v36, v5
v_mul_f32 v37, v37, v5
v_mul_f32 v38, v38, v5
v_mul_f32 v39, v39, v5
v_mul_f32 v40, v40, v5
v_mul_f32 v41, v41, v5
v_mul_f32 v42, v42, v5
v_mul_f32 v43, v43, v5
v_mul_f32 v44, v44, v5
v_mul_f32 v45, v45, v5
v_mul_f32 v46, v46, v5
v_mul_f32 v47, v47, v5
v_mul_f32 v48, v48, v5
v_mul_f32 v49, v49, v5
v_mul_f32 v50, v50, v5
v_mul_f32 v51, v51, v5
v_mul_f32 v52, v52, v5
v_mul_f32 v53, v53, v5
v_mul_f32 v54, v54, v5
v_mul_f32 v55, v55, v5
v_mul_f32 v56, v56, v5
v_mul_f32 v57, v57, v5
v_mul_f32 v58, v58, v5
v_mul_f32 v59, v59, v5
v_mul_f32 v60, v60, v5
v_mul_f32 v61, v61, v5
v_mul_f32 v62, v62, v5
v_mul_f32 v63, v63, v5
v_mul_f32 v64, v64, v5
v_mul_f32 v65, v65, v5
v_mul_f32 v66, v66, v5
v_mul_f32 v67, v67, v5
v_mul_f32 v68, v68, v5
v_mul_f32 v69, v69, v5
v_mul_f32 v70, v70, v5
v_mul_f32 v71, v71, v5
v_mul_f32 v72, v72, v5
v_mul_f32 v73, v73, v5
v_mul_f32 v74, v74, v5
v_mul_f32 v75, v75, v5
v_mul_f32 v76, v76, v5
v_mul_f32 v77, v77, v5
v_mul_f32 v78, v78, v5
v_mul_f32 v79, v79, v5
v_mul_f32 v80, v80, v5
v_mul_f32 v81, v81, v5
v_mul_f32 v82, v82, v5
v_mul_f32 v83, v83, v5
v_mul_f32 v84, v84, v5
v_mul_f32 v85, v85, v5
v_mul_f32 v86, v86, v5
v_mul_f32 v87, v87, v5
v_mul_f32 v88, v88, v5
v_mul_f32 v89, v89, v5
v_mul_f32 v90, v90, v5
v_mul_f32 v91, v91, v5
v_mul_f32 v92, v92, v5
v_mul_f32 v93, v93, v5
v_mul_f32 v94, v94, v5
v_mul_f32 v95, v95, v5
s_nop 1
s_branch c1_rb27
c1_rs28:
v_mov_b32 v5, v4
s_nop 1
v_permlane32_swap_b32 v4, v5
v_max_f32 v4, v4, v5
v_max_f32 v4, 0, v4
v_exp_f32 v5, -v4
s_nop 7
v_sub_f32 v176, v176, v4
v_sub_f32 v177, v177, v4
v_sub_f32 v178, v178, v4
v_sub_f32 v179, v179, v4
v_sub_f32 v180, v180, v4
v_sub_f32 v181, v181, v4
v_sub_f32 v182, v182, v4
v_sub_f32 v183, v183, v4
v_sub_f32 v184, v184, v4
v_sub_f32 v185, v185, v4
v_sub_f32 v186, v186, v4
v_sub_f32 v187, v187, v4
v_sub_f32 v188, v188, v4
v_sub_f32 v189, v189, v4
v_sub_f32 v190, v190, v4
v_sub_f32 v191, v191, v4
v_sub_f32 v160, v160, v4
v_sub_f32 v161, v161, v4
v_sub_f32 v162, v162, v4
v_sub_f32 v163, v163, v4
v_sub_f32 v164, v164, v4
v_sub_f32 v165, v165, v4
v_sub_f32 v166, v166, v4
v_sub_f32 v167, v167, v4
v_sub_f32 v168, v168, v4
v_sub_f32 v169, v169, v4
v_sub_f32 v170, v170, v4
v_sub_f32 v171, v171, v4
v_sub_f32 v172, v172, v4
v_sub_f32 v173, v173, v4
v_sub_f32 v174, v174, v4
v_sub_f32 v175, v175, v4
v_mul_f32 v2, v2, v5
v_mul_f32 v3, v3, v5
v_mul_f32 v32, v32, v5
v_mul_f32 v33, v33, v5
v_mul_f32 v34, v34, v5
v_mul_f32 v35, v35, v5
v_mul_f32 v36, v36, v5
v_mul_f32 v37, v37, v5
v_mul_f32 v38, v38, v5
v_mul_f32 v39, v39, v5
v_mul_f32 v40, v40, v5
v_mul_f32 v41, v41, v5
v_mul_f32 v42, v42, v5
v_mul_f32 v43, v43, v5
v_mul_f32 v44, v44, v5
v_mul_f32 v45, v45, v5
v_mul_f32 v46, v46, v5
v_mul_f32 v47, v47, v5
v_mul_f32 v48, v48, v5
v_mul_f32 v49, v49, v5
v_mul_f32 v50, v50, v5
v_mul_f32 v51, v51, v5
v_mul_f32 v52, v52, v5
v_mul_f32 v53, v53, v5
v_mul_f32 v54, v54, v5
v_mul_f32 v55, v55, v5
v_mul_f32 v56, v56, v5
v_mul_f32 v57, v57, v5
v_mul_f32 v58, v58, v5
v_mul_f32 v59, v59, v5
v_mul_f32 v60, v60, v5
v_mul_f32 v61, v61, v5
v_mul_f32 v62, v62, v5
v_mul_f32 v63, v63, v5
v_mul_f32 v64, v64, v5
v_mul_f32 v65, v65, v5
v_mul_f32 v66, v66, v5
v_mul_f32 v67, v67, v5
v_mul_f32 v68, v68, v5
v_mul_f32 v69, v69, v5
v_mul_f32 v70, v70, v5
v_mul_f32 v71, v71, v5
v_mul_f32 v72, v72, v5
v_mul_f32 v73, v73, v5
v_mul_f32 v74, v74, v5
v_mul_f32 v75, v75, v5
v_mul_f32 v76, v76, v5
v_mul_f32 v77, v77, v5
v_mul_f32 v78, v78, v5
v_mul_f32 v79, v79, v5
v_mul_f32 v80, v80, v5
v_mul_f32 v81, v81, v5
v_mul_f32 v82, v82, v5
v_mul_f32 v83, v83, v5
v_mul_f32 v84, v84, v5
v_mul_f32 v85, v85, v5
v_mul_f32 v86, v86, v5
v_mul_f32 v87, v87, v5
v_mul_f32 v88, v88, v5
v_mul_f32 v89, v89, v5
v_mul_f32 v90, v90, v5
v_mul_f32 v91, v91, v5
v_mul_f32 v92, v92, v5
v_mul_f32 v93, v93, v5
v_mul_f32 v94, v94, v5
v_mul_f32 v95, v95, v5
s_nop 1
s_branch c1_rb28
c1_rs29:
v_mov_b32 v5, v4
s_nop 1
v_permlane32_swap_b32 v4, v5
v_max_f32 v4, v4, v5
v_max_f32 v4, 0, v4
v_exp_f32 v5, -v4
s_nop 7
v_sub_f32 v192, v192, v4
v_sub_f32 v193, v193, v4
v_sub_f32 v194, v194, v4
v_sub_f32 v195, v195, v4
v_sub_f32 v196, v196, v4
v_sub_f32 v197, v197, v4
v_sub_f32 v198, v198, v4
v_sub_f32 v199, v199, v4
v_sub_f32 v200, v200, v4
v_sub_f32 v201, v201, v4
v_sub_f32 v202, v202, v4
v_sub_f32 v203, v203, v4
v_sub_f32 v204, v204, v4
v_sub_f32 v205, v205, v4
v_sub_f32 v206, v206, v4
v_sub_f32 v207, v207, v4
v_sub_f32 v160, v160, v4
v_sub_f32 v161, v161, v4
v_sub_f32 v162, v162, v4
v_sub_f32 v163, v163, v4
v_sub_f32 v164, v164, v4
v_sub_f32 v165, v165, v4
v_sub_f32 v166, v166, v4
v_sub_f32 v167, v167, v4
v_sub_f32 v168, v168, v4
v_sub_f32 v169, v169, v4
v_sub_f32 v170, v170, v4
v_sub_f32 v171, v171, v4
v_sub_f32 v172, v172, v4
v_sub_f32 v173, v173, v4
v_sub_f32 v174, v174, v4
v_sub_f32 v175, v175, v4
v_mul_f32 v2, v2, v5
v_mul_f32 v3, v3, v5
v_mul_f32 v32, v32, v5
v_mul_f32 v33, v33, v5
v_mul_f32 v34, v34, v5
v_mul_f32 v35, v35, v5
v_mul_f32 v36, v36, v5
v_mul_f32 v37, v37, v5
v_mul_f32 v38, v38, v5
v_mul_f32 v39, v39, v5
v_mul_f32 v40, v40, v5
v_mul_f32 v41, v41, v5
v_mul_f32 v42, v42, v5
v_mul_f32 v43, v43, v5
v_mul_f32 v44, v44, v5
v_mul_f32 v45, v45, v5
v_mul_f32 v46, v46, v5
v_mul_f32 v47, v47, v5
v_mul_f32 v48, v48, v5
v_mul_f32 v49, v49, v5
v_mul_f32 v50, v50, v5
v_mul_f32 v51, v51, v5
v_mul_f32 v52, v52, v5
v_mul_f32 v53, v53, v5
v_mul_f32 v54, v54, v5
v_mul_f32 v55, v55, v5
v_mul_f32 v56, v56, v5
v_mul_f32 v57, v57, v5
v_mul_f32 v58, v58, v5
v_mul_f32 v59, v59, v5
v_mul_f32 v60, v60, v5
v_mul_f32 v61, v61, v5
v_mul_f32 v62, v62, v5
v_mul_f32 v63, v63, v5
v_mul_f32 v64, v64, v5
v_mul_f32 v65, v65, v5
v_mul_f32 v66, v66, v5
v_mul_f32 v67, v67, v5
v_mul_f32 v68, v68, v5
v_mul_f32 v69, v69, v5
v_mul_f32 v70, v70, v5
v_mul_f32 v71, v71, v5
v_mul_f32 v72, v72, v5
v_mul_f32 v73, v73, v5
v_mul_f32 v74, v74, v5
v_mul_f32 v75, v75, v5
v_mul_f32 v76, v76, v5
v_mul_f32 v77, v77, v5
v_mul_f32 v78, v78, v5
v_mul_f32 v79, v79, v5
v_mul_f32 v80, v80, v5
v_mul_f32 v81, v81, v5
v_mul_f32 v82, v82, v5
v_mul_f32 v83, v83, v5
v_mul_f32 v84, v84, v5
v_mul_f32 v85, v85, v5
v_mul_f32 v86, v86, v5
v_mul_f32 v87, v87, v5
v_mul_f32 v88, v88, v5
v_mul_f32 v89, v89, v5
v_mul_f32 v90, v90, v5
v_mul_f32 v91, v91, v5
v_mul_f32 v92, v92, v5
v_mul_f32 v93, v93, v5
v_mul_f32 v94, v94, v5
v_mul_f32 v95, v95, v5
s_nop 1
s_branch c1_rb29
c1_rs30:
v_mov_b32 v5, v4
s_nop 1
v_permlane32_swap_b32 v4, v5
v_max_f32 v4, v4, v5
v_max_f32 v4, 0, v4
v_exp_f32 v5, -v4
s_nop 7
v_sub_f32 v176, v176, v4
v_sub_f32 v177, v177, v4
v_sub_f32 v178, v178, v4
v_sub_f32 v179, v179, v4
v_sub_f32 v180, v180, v4
v_sub_f32 v181, v181, v4
v_sub_f32 v182, v182, v4
v_sub_f32 v183, v183, v4
v_sub_f32 v184, v184, v4
v_sub_f32 v185, v185, v4
v_sub_f32 v186, v186, v4
v_sub_f32 v187, v187, v4
v_sub_f32 v188, v188, v4
v_sub_f32 v189, v189, v4
v_sub_f32 v190, v190, v4
v_sub_f32 v191, v191, v4
v_sub_f32 v160, v160, v4
v_sub_f32 v161, v161, v4
v_sub_f32 v162, v162, v4
v_sub_f32 v163, v163, v4
v_sub_f32 v164, v164, v4
v_sub_f32 v165, v165, v4
v_sub_f32 v166, v166, v4
v_sub_f32 v167, v167, v4
v_sub_f32 v168, v168, v4
v_sub_f32 v169, v169, v4
v_sub_f32 v170, v170, v4
v_sub_f32 v171, v171, v4
v_sub_f32 v172, v172, v4
v_sub_f32 v173, v173, v4
v_sub_f32 v174, v174, v4
v_sub_f32 v175, v175, v4
v_mul_f32 v2, v2, v5
v_mul_f32 v3, v3, v5
v_mul_f32 v32, v32, v5
v_mul_f32 v33, v33, v5
v_mul_f32 v34, v34, v5
v_mul_f32 v35, v35, v5
v_mul_f32 v36, v36, v5
v_mul_f32 v37, v37, v5
v_mul_f32 v38, v38, v5
v_mul_f32 v39, v39, v5
v_mul_f32 v40, v40, v5
v_mul_f32 v41, v41, v5
v_mul_f32 v42, v42, v5
v_mul_f32 v43, v43, v5
v_mul_f32 v44, v44, v5
v_mul_f32 v45, v45, v5
v_mul_f32 v46, v46, v5
v_mul_f32 v47, v47, v5
v_mul_f32 v48, v48, v5
v_mul_f32 v49, v49, v5
v_mul_f32 v50, v50, v5
v_mul_f32 v51, v51, v5
v_mul_f32 v52, v52, v5
v_mul_f32 v53, v53, v5
v_mul_f32 v54, v54, v5
v_mul_f32 v55, v55, v5
v_mul_f32 v56, v56, v5
v_mul_f32 v57, v57, v5
v_mul_f32 v58, v58, v5
v_mul_f32 v59, v59, v5
v_mul_f32 v60, v60, v5
v_mul_f32 v61, v61, v5
v_mul_f32 v62, v62, v5
v_mul_f32 v63, v63, v5
v_mul_f32 v64, v64, v5
v_mul_f32 v65, v65, v5
v_mul_f32 v66, v66, v5
v_mul_f32 v67, v67, v5
v_mul_f32 v68, v68, v5
v_mul_f32 v69, v69, v5
v_mul_f32 v70, v70, v5
v_mul_f32 v71, v71, v5
v_mul_f32 v72, v72, v5
v_mul_f32 v73, v73, v5
v_mul_f32 v74, v74, v5
v_mul_f32 v75, v75, v5
v_mul_f32 v76, v76, v5
v_mul_f32 v77, v77, v5
v_mul_f32 v78, v78, v5
v_mul_f32 v79, v79, v5
v_mul_f32 v80, v80, v5
v_mul_f32 v81, v81, v5
v_mul_f32 v82, v82, v5
v_mul_f32 v83, v83, v5
v_mul_f32 v84, v84, v5
v_mul_f32 v85, v85, v5
v_mul_f32 v86, v86, v5
v_mul_f32 v87, v87, v5
v_mul_f32 v88, v88, v5
v_mul_f32 v89, v89, v5
v_mul_f32 v90, v90, v5
v_mul_f32 v91, v91, v5
v_mul_f32 v92, v92, v5
v_mul_f32 v93, v93, v5
v_mul_f32 v94, v94, v5
v_mul_f32 v95, v95, v5
s_nop 1
s_branch c1_rb30
.section .rodata,"a"
.p2align 6
.amdhsa_kernel concat_heads__mha_block_cached__mha_block_cached__near_ridge_kernel
  .amdhsa_next_free_vgpr 256
  .amdhsa_next_free_sgpr 102
  .amdhsa_accum_offset 256
  .amdhsa_group_segment_fixed_size 0
  .amdhsa_kernarg_size 104
  .amdhsa_user_sgpr_count 2
  .amdhsa_user_sgpr_kernarg_segment_ptr 1
  .amdhsa_system_sgpr_workgroup_id_x 1
.end_amdhsa_kernel
```
